```python
import torch

def _softmax(x, axis=-1):
    return torch.softmax(x, dim=axis)
def _gelu(x):
    return torch.nn.functional.gelu(x, approximate="tanh")
def _silu(x):
    return torch.nn.functional.silu(x)
def _sigmoid(x):
    return torch.sigmoid(x)
def _layernorm(x, axis=-1, eps=1e-5):
    m = x.mean(dim=axis, keepdim=True)
    v = x.var(dim=axis, keepdim=True, unbiased=False)
    return (x - m) / torch.sqrt(v + eps)
def _scatter_add(tgt, idx, src, axis=0):
    return tgt.clone().index_add_(axis, idx, src)
def _segment_sum(src, seg, n):
    out = torch.zeros((n,) + src.shape[1:], dtype=src.dtype)
    return out.index_add_(0, seg, src)
def _pad(x, pw):
    flat = tuple(v for pair in reversed(pw) for v in pair)
    return torch.nn.functional.pad(x, flat)

kernel_name = 'standalone__mixer_token_mlp__prompt'

def setup_inputs():

    _w = (lambda a: (lambda t: t.to(torch.bfloat16) if t.is_floating_point() else t)(torch.as_tensor(a)))
    B, S, D, F = 1, 2048, 512, 1376
    return {
        "x": _w((lambda *s: torch.randn(*s, dtype=torch.bfloat16) * 0.05)(B, S, D)),
        "w1": _w((lambda *s: torch.randn(*s, dtype=torch.bfloat16) * 0.2)(S, F) * (S ** -0.5)),
        "b1": _w((lambda *s: torch.randn(*s, dtype=torch.bfloat16) * 1.6)(F) * 0.02),
        "w2": _w((lambda *s: torch.randn(*s, dtype=torch.bfloat16) * 0.05)(F, S) * (F ** -0.5)),
        "b2": _w((lambda *s: torch.randn(*s, dtype=torch.bfloat16) * 0.1)(S) * 0.02),
    }

def reference(x, w1, b1, w2, b2):
    B, S, D = x.shape
    h = _layernorm(x, axis=-1)
    u = torch.einsum("bsd,sf->bdf", h, w1) + b1
    u = _gelu(u)
    y = torch.einsum("bdf,fs->bds", u, w2) + b2
    return (lambda x, *d: x.permute(*d))(y, 0, 2, 1)
```

```asm
; @launch grid=(256,1,1) block=(256,1,1) lds=163840
.amdgcn_target "amdgcn-amd-amdhsa--gfx950"
.text
.globl standalone__mixer_token_mlp__prompt_kernel
.p2align 8
.type standalone__mixer_token_mlp__prompt_kernel,@function
standalone__mixer_token_mlp__prompt_kernel:
    s_load_dwordx16 s[4:19], s[0:1], 0
    s_cmp_ge_u32 s2, 256
    s_cbranch_scc1 L_end
    s_getpc_b64 s[56:57]
L_pc:
    v_lshlrev_b32 v7, 4, v0
    s_lshr_b32 s101, s2, 3
    s_lshl_b32 s66, s101, 12
    s_mov_b32 s58, L_code_end - L_pc
    s_mov_b32 s59, 0x20000
    buffer_load_dwordx4 v[80:83], v7, s[56:59], s66 offen
    v_and_b32 v1, 63, v0
    v_lshrrev_b32 v2, 6, v0
    v_lshlrev_b32 v7, 4, v1
    v_readfirstlane_b32 s60, v2
    s_bfe_u32 s96, s2, 0x10002
    s_and_b32 s61, s2, 3
    s_lshl_b32 s61, s61, 2
    s_lshr_b32 s65, s101, 3
    s_add_u32 s61, s61, s65
    s_and_b32 s62, s101, 7
    s_mul_i32 s74, s65, 0
    s_add_u32 s74, s74, s62
    s_and_b32 s74, s74, 7
    s_min_u32 s66, s61, 14
    s_mul_i32 s66, s66, 192
    s_and_b32 s93, s60, 1
    s_lshl_b32 s65, s96, 4
    s_add_u32 s65, s65, s93
    s_lshl_b32 s65, s65, 1
    s_mul_i32 s68, s65, 88064
    s_add_u32 s68, s68, s66
    s_add_u32 s69, s68, 2818048
    s_mul_i32 s66, s74, 352256
    s_add_u32 s67, s68, s66
    s_mul_i32 s73, s93, 12288
    s_lshl_b32 s59, s96, 5
    s_add_u32 s59, s59, s101
    s_lshl_b32 s59, s59, 2
    s_and_b32 s3, s2, 3
    s_add_u32 s59, s59, s3
    s_lshl_b32 s3, s59, 13
    s_mul_i32 s65, s96, 6
    v_mul_u32_u24 v31, 5462, v1
    v_lshrrev_b32 v31, 16, v31
    v_mul_u32_u24 v3, 12, v31
    v_sub_u32 v3, v1, v3
    v_add_u32 v3, s65, v3
    v_subrev_u32 v26, 12, v3
    v_min_u32 v3, v3, v26
    v_mul_u32_u24 v31, 2752, v31
    v_lshl_add_u32 v4, v3, 4, v31
    v_add_u32 v30, 64, v1
    v_mul_u32_u24 v31, 5462, v30
    v_lshrrev_b32 v31, 16, v31
    v_mul_u32_u24 v3, 12, v31
    v_sub_u32 v3, v30, v3
    v_lshrrev_b32 v26, 2, v31
    v_and_b32 v26, 2, v26
    v_xor_b32 v3, v3, v26
    v_add_u32 v3, s65, v3
    v_subrev_u32 v26, 12, v3
    v_min_u32 v3, v3, v26
    v_mul_u32_u24 v31, 2752, v31
    v_lshl_add_u32 v5, v3, 4, v31
    v_subrev_u32 v5, 1024, v5
    v_add_u32 v30, 128, v1
    v_mul_u32_u24 v31, 5462, v30
    v_lshrrev_b32 v31, 16, v31
    v_mul_u32_u24 v3, 12, v31
    v_sub_u32 v3, v30, v3
    v_lshrrev_b32 v26, 2, v31
    v_and_b32 v26, 2, v26
    v_xor_b32 v3, v3, v26
    v_add_u32 v3, s65, v3
    v_subrev_u32 v26, 12, v3
    v_min_u32 v3, v3, v26
    v_mul_u32_u24 v31, 2752, v31
    v_lshl_add_u32 v6, v3, 4, v31
    v_subrev_u32 v6, 2048, v6
    v_lshrrev_b32 v30, 3, v1
    v_and_b32 v31, 7, v1
    v_lshlrev_b32 v30, 10, v30
    v_lshl_add_u32 v30, v31, 4, v30
    s_lshl_b32 s66, s93, 9
    s_add_u32 s65, s3, s66
    s_xor_b32 s66, s65, 512
    s_mov_b32 s22, 2097152
    s_mov_b32 s23, 0x20000
    s_mov_b32 s26, 5636096
    s_mov_b32 s27, 0x20000
    s_waitcnt lgkmcnt(0)
    s_mov_b32 s20, s4
    s_mov_b32 s21, s5
    s_mov_b32 s24, s6
    s_mov_b32 s25, s7
    s_cmp_ge_u32 s60, 2
    s_cbranch_scc1 L_e1
    buffer_load_dwordx4 v[104:107], v30, s[20:23], s65 offen offset:0
    buffer_load_dwordx4 v[108:111], v30, s[20:23], s65 offen offset:128
    buffer_load_dwordx4 v[112:115], v30, s[20:23], s65 offen offset:256
    buffer_load_dwordx4 v[116:119], v30, s[20:23], s65 offen offset:384
    buffer_load_dwordx4 v[120:123], v30, s[20:23], s66 offen offset:0
    buffer_load_dwordx4 v[124:127], v30, s[20:23], s66 offen offset:128
    buffer_load_dwordx4 v[128:131], v30, s[20:23], s66 offen offset:256
    buffer_load_dwordx4 v[132:135], v30, s[20:23], s66 offen offset:384
    s_branch L_e2
L_e1:
    s_add_u32 m0, s73, 0
    s_add_u32 s98, s67, 0
    buffer_load_dwordx4 v4, s[24:27], s98 offen offset:0 lds
    buffer_load_dwordx4 v5, s[24:27], s98 offen offset:1024 lds
    buffer_load_dwordx4 v6, s[24:27], s98 offen offset:2048 lds
    s_add_u32 m0, s73, 3072
    s_add_u32 s98, s67, 44032
    buffer_load_dwordx4 v4, s[24:27], s98 offen offset:0 lds
    buffer_load_dwordx4 v5, s[24:27], s98 offen offset:1024 lds
    buffer_load_dwordx4 v6, s[24:27], s98 offen offset:2048 lds
    s_add_u32 m0, s73, 6144
    s_add_u32 s98, s67, 88064
    buffer_load_dwordx4 v4, s[24:27], s98 offen offset:0 lds
    buffer_load_dwordx4 v5, s[24:27], s98 offen offset:1024 lds
    buffer_load_dwordx4 v6, s[24:27], s98 offen offset:2048 lds
    s_add_u32 m0, s73, 9216
    s_add_u32 s98, s67, 132096
    buffer_load_dwordx4 v4, s[24:27], s98 offen offset:0 lds
    buffer_load_dwordx4 v5, s[24:27], s98 offen offset:1024 lds
    buffer_load_dwordx4 v6, s[24:27], s98 offen offset:2048 lds
    s_add_u32 s67, s67, 352256
    s_cmp_ge_u32 s67, s69
    s_cselect_b32 s67, s68, s67
L_e2:
    s_mov_b32 s3, 4190208
    s_load_dword s97, s[18:19], s3
    s_and_b32 s65, s2, 7
    s_lshl_b32 s63, s65, 2
    s_lshr_b32 s64, s101, 3
    s_add_u32 s63, s63, s64
    s_and_b32 s64, s101, 7
    s_mov_b32 s28, s10
    s_mov_b32 s29, s11
    s_mov_b32 s30, 5636096
    s_mov_b32 s31, 0x20000
    s_mov_b32 s32, s18
    s_mov_b32 s33, s19
    s_mov_b32 s34, 2097152
    s_mov_b32 s35, 0x20000
    s_add_u32 s36, s18, 2097152
    s_addc_u32 s37, s19, 0
    s_mov_b32 s38, 1409024
    s_mov_b32 s39, 0x20000
    s_add_u32 s44, s18, 4128768
    s_addc_u32 s45, s19, 0
    s_mov_b32 s46, 65536
    s_mov_b32 s47, 0x20000
    s_mov_b32 s40, s14
    s_mov_b32 s41, s15
    s_mov_b32 s42, 2097152
    s_mov_b32 s43, 0x20000
    s_mov_b32 s48, s8
    s_mov_b32 s49, s9
    s_mov_b32 s50, 2752
    s_mov_b32 s51, 0x20000
    s_mov_b32 s52, s12
    s_mov_b32 s53, s13
    s_mov_b32 s54, 4096
    s_mov_b32 s55, 0x20000
    s_add_u32 s8, s18, 4194304
    s_addc_u32 s9, s19, 0
    s_mov_b32 s10, 4194304
    s_mov_b32 s11, 0x20000
    s_and_b32 s91, s60, 1
    s_lshl_b32 s91, s91, 1
    s_lshr_b32 s66, s60, 1
    s_add_u32 s91, s91, s66
    s_lshl_b32 s100, s62, 2
    s_add_u32 s100, s100, s91
    s_lshl_b32 s100, s100, 10
    s_lshl_b32 s71, s96, 20
    s_lshl_b32 s66, s62, 10
    s_add_u32 s71, s71, s66
    s_add_u32 s72, s71, 1048576
    s_add_u32 s66, s74, 0
    s_and_b32 s66, s66, 7
    s_lshl_b32 s66, s66, 17
    s_add_u32 s70, s71, s66
    s_lshl_b32 s65, s93, 1
    s_sub_u32 s65, s60, s65
    s_mul_i32 s65, s65, 88064
    s_add_u32 s65, s65, s68
    s_mul_i32 s12, s60, 6144
    s_add_u32 s66, s74, 6
    s_and_b32 s66, s66, 7
    s_mul_i32 s66, s66, 352256
    s_add_u32 s94, s65, s66
    s_add_u32 s66, s74, 7
    s_and_b32 s66, s66, 7
    s_mul_i32 s66, s66, 352256
    s_add_u32 s95, s65, s66
    s_mul_i32 s99, s61, 6
    s_mul_i32 s66, s96, 3
    s_add_u32 s99, s99, s66
    s_lshl_b32 s5, s60, 12
    s_lshl_b32 s6, s2, 14
    s_add_u32 s6, s6, s5
    s_xor_b32 s7, s6, 65536
    v_lshrrev_b32 v3, 4, v1
    v_bfe_u32 v30, v1, 2, 2
    v_and_b32 v31, 3, v1
    v_mul_u32_u24 v84, 1056, v30
    v_lshl_add_u32 v84, v3, 5, v84
    v_lshl_add_u32 v84, v31, 3, v84
    v_lshl_add_u32 v84, v2, 9, v84
    v_add_u32 v84, 147456, v84
    v_lshrrev_b32 v85, 3, v1
    v_mul_u32_u24 v85, 1056, v85
    v_and_b32 v86, 7, v1
    v_lshl_add_u32 v85, v86, 4, v85
    v_lshl_add_u32 v85, v2, 9, v85
    v_add_u32 v85, 147456, v85
    v_lshl_add_u32 v86, v3, 3, v30
    v_mul_u32_u24 v87, 192, v86
    v_lshl_add_u32 v87, v31, 3, v87
    v_and_b32 v26, 1, v3
    v_lshrrev_b32 v28, 1, v2
    v_mul_u32_u24 v29, 12288, v28
    v_add_u32 v87, v87, v29
    v_lshl_add_u32 v20, v26, 5, v87
    v_xor_b32 v21, 32, v20
    v_add_u32 v22, 49152, v20
    v_add_u32 v23, 49152, v21
    v_add_u32 v24, 98304, v20
    v_add_u32 v25, 98304, v21
    v_lshlrev_b32 v86, 7, v86
    v_lshl_add_u32 v86, v31, 3, v86
    v_lshl_add_u32 v86, v28, 13, v86
    v_lshrrev_b32 v30, 1, v30
    v_lshl_or_b32 v30, v26, 1, v30
    v_lshl_add_u32 v232, v30, 5, v86
    v_xor_b32 v233, 32, v232
    v_xor_b32 v234, 64, v232
    v_xor_b32 v235, 96, v232
    v_add_u32 v236, 65536, v232
    v_add_u32 v237, 65536, v233
    v_add_u32 v238, 65536, v234
    v_add_u32 v239, 65536, v235
    v_add_u32 v240, 131072, v232
    v_add_u32 v241, 131072, v233
    v_add_u32 v242, 131072, v234
    v_add_u32 v243, 131072, v235
    v_and_b32 v86, 15, v1
    v_lshlrev_b32 v86, 4, v86
    v_lshrrev_b32 v30, 1, v3
    v_lshl_add_u32 v27, v30, 8, v86
    v_add_u32 v30, s99, v26
    v_lshrrev_b32 v31, 1, v30
    v_and_b32 v30, 1, v30
    v_lshl_add_u32 v27, v31, 15, v27
    v_lshl_add_u32 v30, v30, 9, v27
    v_lshl_add_u32 v27, v26, 30, v30
    v_add_u32 v27, 32768, v27
    v_mov_b32 v26, v30
    v_lshl_add_u32 v86, v3, 13, v86
    v_lshl_add_u32 v86, v28, 16, v86
    v_lshl_add_u32 v87, v28, 16, v7
    s_xor_b32 s65, s91, 0
    s_lshl_b32 s66, s65, 8
    s_lshl_b32 s65, s65, 10
    v_add_u32 v12, s66, v86
    v_add_u32 v16, s65, v87
    v_add_u32 v14, 32768, v12
    v_add_u32 v18, 32768, v16
    s_xor_b32 s65, s91, 1
    s_lshl_b32 s66, s65, 8
    s_lshl_b32 s65, s65, 10
    v_add_u32 v13, s66, v86
    v_add_u32 v17, s65, v87
    v_add_u32 v15, 32768, v13
    v_add_u32 v19, 32768, v17
    v_mul_u32_u24 v253, 6144, v2
    v_add_u32 v253, 98304, v253
    v_add_u32 v253, v253, v7
    v_xor_b32 v254, 2, v2
    v_mul_u32_u24 v254, 6144, v254
    v_add_u32 v254, 98304, v254
    v_add_u32 v254, v254, v7
    v_lshrrev_b32 v30, 3, v1
    v_and_b32 v31, 7, v1
    v_bfe_u32 v86, v1, 4, 1
    v_lshlrev_b32 v86, 1, v86
    v_xor_b32 v31, v31, v86
    v_lshlrev_b32 v30, 12, v30
    v_xor_b32 v86, 4, v31
    v_lshl_add_u32 v8, v31, 4, v30
    v_lshl_add_u32 v9, v86, 4, v30
    v_add_u32 v10, 63488, v8
    v_add_u32 v11, 95232, v9
    v_add_u32 v9, 31744, v9
    s_mul_i32 s65, s63, 0
    s_mul_i32 s66, s64, 1
    s_add_u32 s65, s65, s66
    s_and_b32 s65, s65, 7
    s_mul_i32 s74, s65, 11
    s_lshr_b32 s74, s74, 3
    s_mul_i32 s57, s60, 131072
    s_lshl_b32 s66, s63, 7
    s_add_u32 s57, s57, s66
    s_add_u32 s58, s57, 5767168
    s_mul_i32 s66, s74, 524288
    s_add_u32 s56, s57, s66
    s_lshl_b32 s65, s64, 12
    s_add_u32 s3, s65, 1441792
    s_lshl_b32 s66, s74, 17
    s_add_u32 s80, s65, s66
    s_add_u32 s81, s80, 131072
    s_cmp_ge_u32 s81, s3
    s_cselect_b32 s81, s65, s81
    s_add_u32 s82, s81, 131072
    s_cmp_ge_u32 s82, s3
    s_cselect_b32 s82, s65, s82
    s_add_u32 s83, s82, 131072
    s_cmp_ge_u32 s83, s3
    s_cselect_b32 s83, s65, s83
    s_add_u32 s84, s83, 131072
    s_cmp_ge_u32 s84, s3
    s_cselect_b32 s84, s65, s84
    s_add_u32 s85, s84, 131072
    s_cmp_ge_u32 s85, s3
    s_cselect_b32 s85, s65, s85
    s_add_u32 s86, s85, 131072
    s_cmp_ge_u32 s86, s3
    s_cselect_b32 s86, s65, s86
    s_add_u32 s87, s86, 131072
    s_cmp_ge_u32 s87, s3
    s_cselect_b32 s87, s65, s87
    s_add_u32 s88, s87, 131072
    s_cmp_ge_u32 s88, s3
    s_cselect_b32 s88, s65, s88
    s_add_u32 s89, s88, 131072
    s_cmp_ge_u32 s89, s3
    s_cselect_b32 s89, s65, s89
    s_add_u32 s90, s89, 131072
    s_cmp_ge_u32 s90, s3
    s_cselect_b32 s90, s65, s90
    v_mov_b32 v88, -1
    v_mov_b32 v89, -1
    v_mov_b32 v90, -1
    v_mov_b32 v91, -1
    v_mov_b64 v[32:33], 0
    v_mov_b64 v[34:35], 0
    v_mov_b64 v[36:37], 0
    v_mov_b64 v[38:39], 0
    v_mov_b64 v[40:41], 0
    v_mov_b64 v[42:43], 0
    v_mov_b64 v[44:45], 0
    v_mov_b64 v[46:47], 0
    v_mov_b64 v[48:49], 0
    v_mov_b64 v[50:51], 0
    v_mov_b64 v[52:53], 0
    v_mov_b64 v[54:55], 0
    v_mov_b64 v[56:57], 0
    v_mov_b64 v[58:59], 0
    v_mov_b64 v[60:61], 0
    v_mov_b64 v[62:63], 0
    v_mov_b64 v[64:65], 0
    v_mov_b64 v[66:67], 0
    v_mov_b64 v[68:69], 0
    v_mov_b64 v[70:71], 0
    v_mov_b64 v[72:73], 0
    v_mov_b64 v[74:75], 0
    v_mov_b64 v[76:77], 0
    v_mov_b64 v[78:79], 0
    s_cmp_ge_u32 s60, 2
    s_cbranch_scc1 L_ldpath
    s_waitcnt vmcnt(7)
    v_lshlrev_b32 v180, 16, v104
    s_nop 1
    v_mov_b32_dpp v180, v180 quad_perm:[0,0,0,0] row_mask:0xf bank_mask:0xf
    s_nop 1
    v_mov_b32_dpp v180, v180 row_shr:4 row_mask:0xf bank_mask:0xa
    v_lshlrev_b32 v136, 16, v104
    v_and_b32 v137, 0xffff0000, v104
    v_lshlrev_b32 v138, 16, v105
    v_and_b32 v139, 0xffff0000, v105
    v_lshlrev_b32 v140, 16, v106
    v_and_b32 v141, 0xffff0000, v106
    v_lshlrev_b32 v142, 16, v107
    v_and_b32 v143, 0xffff0000, v107
    v_pk_add_f32 v[136:137], v[136:137], v[180:181] op_sel_hi:[1,0] neg_lo:[0,1] neg_hi:[0,1]
    v_pk_add_f32 v[138:139], v[138:139], v[180:181] op_sel_hi:[1,0] neg_lo:[0,1] neg_hi:[0,1]
    v_pk_add_f32 v[140:141], v[140:141], v[180:181] op_sel_hi:[1,0] neg_lo:[0,1] neg_hi:[0,1]
    v_pk_add_f32 v[142:143], v[142:143], v[180:181] op_sel_hi:[1,0] neg_lo:[0,1] neg_hi:[0,1]
    v_mov_b64 v[176:177], v[136:137]
    v_pk_mul_f32 v[178:179], v[136:137], v[136:137]
    v_pk_add_f32 v[176:177], v[176:177], v[138:139]
    v_pk_fma_f32 v[178:179], v[138:139], v[138:139], v[178:179]
    v_pk_add_f32 v[176:177], v[176:177], v[140:141]
    v_pk_fma_f32 v[178:179], v[140:141], v[140:141], v[178:179]
    v_pk_add_f32 v[176:177], v[176:177], v[142:143]
    v_pk_fma_f32 v[178:179], v[142:143], v[142:143], v[178:179]
    s_waitcnt vmcnt(6)
    v_lshlrev_b32 v144, 16, v108
    v_and_b32 v145, 0xffff0000, v108
    v_lshlrev_b32 v146, 16, v109
    v_and_b32 v147, 0xffff0000, v109
    v_lshlrev_b32 v148, 16, v110
    v_and_b32 v149, 0xffff0000, v110
    v_lshlrev_b32 v150, 16, v111
    v_and_b32 v151, 0xffff0000, v111
    v_pk_add_f32 v[144:145], v[144:145], v[180:181] op_sel_hi:[1,0] neg_lo:[0,1] neg_hi:[0,1]
    v_pk_add_f32 v[146:147], v[146:147], v[180:181] op_sel_hi:[1,0] neg_lo:[0,1] neg_hi:[0,1]
    v_pk_add_f32 v[148:149], v[148:149], v[180:181] op_sel_hi:[1,0] neg_lo:[0,1] neg_hi:[0,1]
    v_pk_add_f32 v[150:151], v[150:151], v[180:181] op_sel_hi:[1,0] neg_lo:[0,1] neg_hi:[0,1]
    v_pk_add_f32 v[176:177], v[176:177], v[144:145]
    v_pk_fma_f32 v[178:179], v[144:145], v[144:145], v[178:179]
    v_pk_add_f32 v[176:177], v[176:177], v[146:147]
    v_pk_fma_f32 v[178:179], v[146:147], v[146:147], v[178:179]
    v_pk_add_f32 v[176:177], v[176:177], v[148:149]
    v_pk_fma_f32 v[178:179], v[148:149], v[148:149], v[178:179]
    v_pk_add_f32 v[176:177], v[176:177], v[150:151]
    v_pk_fma_f32 v[178:179], v[150:151], v[150:151], v[178:179]
    s_waitcnt vmcnt(5)
    v_lshlrev_b32 v152, 16, v112
    v_and_b32 v153, 0xffff0000, v112
    v_lshlrev_b32 v154, 16, v113
    v_and_b32 v155, 0xffff0000, v113
    v_lshlrev_b32 v156, 16, v114
    v_and_b32 v157, 0xffff0000, v114
    v_lshlrev_b32 v158, 16, v115
    v_and_b32 v159, 0xffff0000, v115
    v_pk_add_f32 v[152:153], v[152:153], v[180:181] op_sel_hi:[1,0] neg_lo:[0,1] neg_hi:[0,1]
    v_pk_add_f32 v[154:155], v[154:155], v[180:181] op_sel_hi:[1,0] neg_lo:[0,1] neg_hi:[0,1]
    v_pk_add_f32 v[156:157], v[156:157], v[180:181] op_sel_hi:[1,0] neg_lo:[0,1] neg_hi:[0,1]
    v_pk_add_f32 v[158:159], v[158:159], v[180:181] op_sel_hi:[1,0] neg_lo:[0,1] neg_hi:[0,1]
    v_pk_add_f32 v[176:177], v[176:177], v[152:153]
    v_pk_fma_f32 v[178:179], v[152:153], v[152:153], v[178:179]
    v_pk_add_f32 v[176:177], v[176:177], v[154:155]
    v_pk_fma_f32 v[178:179], v[154:155], v[154:155], v[178:179]
    v_pk_add_f32 v[176:177], v[176:177], v[156:157]
    v_pk_fma_f32 v[178:179], v[156:157], v[156:157], v[178:179]
    v_pk_add_f32 v[176:177], v[176:177], v[158:159]
    v_pk_fma_f32 v[178:179], v[158:159], v[158:159], v[178:179]
    s_waitcnt vmcnt(4)
    v_lshlrev_b32 v160, 16, v116
    v_and_b32 v161, 0xffff0000, v116
    v_lshlrev_b32 v162, 16, v117
    v_and_b32 v163, 0xffff0000, v117
    v_lshlrev_b32 v164, 16, v118
    v_and_b32 v165, 0xffff0000, v118
    v_lshlrev_b32 v166, 16, v119
    v_and_b32 v167, 0xffff0000, v119
    v_pk_add_f32 v[160:161], v[160:161], v[180:181] op_sel_hi:[1,0] neg_lo:[0,1] neg_hi:[0,1]
    v_pk_add_f32 v[162:163], v[162:163], v[180:181] op_sel_hi:[1,0] neg_lo:[0,1] neg_hi:[0,1]
    v_pk_add_f32 v[164:165], v[164:165], v[180:181] op_sel_hi:[1,0] neg_lo:[0,1] neg_hi:[0,1]
    v_pk_add_f32 v[166:167], v[166:167], v[180:181] op_sel_hi:[1,0] neg_lo:[0,1] neg_hi:[0,1]
    v_pk_add_f32 v[176:177], v[176:177], v[160:161]
    v_pk_fma_f32 v[178:179], v[160:161], v[160:161], v[178:179]
    v_pk_add_f32 v[176:177], v[176:177], v[162:163]
    v_pk_fma_f32 v[178:179], v[162:163], v[162:163], v[178:179]
    v_pk_add_f32 v[176:177], v[176:177], v[164:165]
    v_pk_fma_f32 v[178:179], v[164:165], v[164:165], v[178:179]
    v_pk_add_f32 v[176:177], v[176:177], v[166:167]
    v_pk_fma_f32 v[178:179], v[166:167], v[166:167], v[178:179]
    s_waitcnt vmcnt(3)
    v_lshlrev_b32 v168, 16, v120
    v_and_b32 v169, 0xffff0000, v120
    v_lshlrev_b32 v170, 16, v121
    v_and_b32 v171, 0xffff0000, v121
    v_lshlrev_b32 v172, 16, v122
    v_and_b32 v173, 0xffff0000, v122
    v_lshlrev_b32 v174, 16, v123
    v_and_b32 v175, 0xffff0000, v123
    v_pk_add_f32 v[168:169], v[168:169], v[180:181] op_sel_hi:[1,0] neg_lo:[0,1] neg_hi:[0,1]
    v_pk_add_f32 v[170:171], v[170:171], v[180:181] op_sel_hi:[1,0] neg_lo:[0,1] neg_hi:[0,1]
    v_pk_add_f32 v[172:173], v[172:173], v[180:181] op_sel_hi:[1,0] neg_lo:[0,1] neg_hi:[0,1]
    v_pk_add_f32 v[174:175], v[174:175], v[180:181] op_sel_hi:[1,0] neg_lo:[0,1] neg_hi:[0,1]
    v_pk_add_f32 v[176:177], v[176:177], v[168:169]
    v_pk_fma_f32 v[178:179], v[168:169], v[168:169], v[178:179]
    v_pk_add_f32 v[176:177], v[176:177], v[170:171]
    v_pk_fma_f32 v[178:179], v[170:171], v[170:171], v[178:179]
    v_pk_add_f32 v[176:177], v[176:177], v[172:173]
    v_pk_fma_f32 v[178:179], v[172:173], v[172:173], v[178:179]
    v_pk_add_f32 v[176:177], v[176:177], v[174:175]
    v_pk_fma_f32 v[178:179], v[174:175], v[174:175], v[178:179]
    s_waitcnt vmcnt(2)
    v_lshlrev_b32 v168, 16, v124
    v_and_b32 v169, 0xffff0000, v124
    v_lshlrev_b32 v170, 16, v125
    v_and_b32 v171, 0xffff0000, v125
    v_lshlrev_b32 v172, 16, v126
    v_and_b32 v173, 0xffff0000, v126
    v_lshlrev_b32 v174, 16, v127
    v_and_b32 v175, 0xffff0000, v127
    v_pk_add_f32 v[168:169], v[168:169], v[180:181] op_sel_hi:[1,0] neg_lo:[0,1] neg_hi:[0,1]
    v_pk_add_f32 v[170:171], v[170:171], v[180:181] op_sel_hi:[1,0] neg_lo:[0,1] neg_hi:[0,1]
    v_pk_add_f32 v[172:173], v[172:173], v[180:181] op_sel_hi:[1,0] neg_lo:[0,1] neg_hi:[0,1]
    v_pk_add_f32 v[174:175], v[174:175], v[180:181] op_sel_hi:[1,0] neg_lo:[0,1] neg_hi:[0,1]
    v_pk_add_f32 v[176:177], v[176:177], v[168:169]
    v_pk_fma_f32 v[178:179], v[168:169], v[168:169], v[178:179]
    v_pk_add_f32 v[176:177], v[176:177], v[170:171]
    v_pk_fma_f32 v[178:179], v[170:171], v[170:171], v[178:179]
    v_pk_add_f32 v[176:177], v[176:177], v[172:173]
    v_pk_fma_f32 v[178:179], v[172:173], v[172:173], v[178:179]
    v_pk_add_f32 v[176:177], v[176:177], v[174:175]
    v_pk_fma_f32 v[178:179], v[174:175], v[174:175], v[178:179]
    s_waitcnt vmcnt(1)
    v_lshlrev_b32 v168, 16, v128
    v_and_b32 v169, 0xffff0000, v128
    v_lshlrev_b32 v170, 16, v129
    v_and_b32 v171, 0xffff0000, v129
    v_lshlrev_b32 v172, 16, v130
    v_and_b32 v173, 0xffff0000, v130
    v_lshlrev_b32 v174, 16, v131
    v_and_b32 v175, 0xffff0000, v131
    v_pk_add_f32 v[168:169], v[168:169], v[180:181] op_sel_hi:[1,0] neg_lo:[0,1] neg_hi:[0,1]
    v_pk_add_f32 v[170:171], v[170:171], v[180:181] op_sel_hi:[1,0] neg_lo:[0,1] neg_hi:[0,1]
    v_pk_add_f32 v[172:173], v[172:173], v[180:181] op_sel_hi:[1,0] neg_lo:[0,1] neg_hi:[0,1]
    v_pk_add_f32 v[174:175], v[174:175], v[180:181] op_sel_hi:[1,0] neg_lo:[0,1] neg_hi:[0,1]
    v_pk_add_f32 v[176:177], v[176:177], v[168:169]
    v_pk_fma_f32 v[178:179], v[168:169], v[168:169], v[178:179]
    v_pk_add_f32 v[176:177], v[176:177], v[170:171]
    v_pk_fma_f32 v[178:179], v[170:171], v[170:171], v[178:179]
    v_pk_add_f32 v[176:177], v[176:177], v[172:173]
    v_pk_fma_f32 v[178:179], v[172:173], v[172:173], v[178:179]
    v_pk_add_f32 v[176:177], v[176:177], v[174:175]
    v_pk_fma_f32 v[178:179], v[174:175], v[174:175], v[178:179]
    s_waitcnt vmcnt(0)
    v_lshlrev_b32 v168, 16, v132
    v_and_b32 v169, 0xffff0000, v132
    v_lshlrev_b32 v170, 16, v133
    v_and_b32 v171, 0xffff0000, v133
    v_lshlrev_b32 v172, 16, v134
    v_and_b32 v173, 0xffff0000, v134
    v_lshlrev_b32 v174, 16, v135
    v_and_b32 v175, 0xffff0000, v135
    v_pk_add_f32 v[168:169], v[168:169], v[180:181] op_sel_hi:[1,0] neg_lo:[0,1] neg_hi:[0,1]
    v_pk_add_f32 v[170:171], v[170:171], v[180:181] op_sel_hi:[1,0] neg_lo:[0,1] neg_hi:[0,1]
    v_pk_add_f32 v[172:173], v[172:173], v[180:181] op_sel_hi:[1,0] neg_lo:[0,1] neg_hi:[0,1]
    v_pk_add_f32 v[174:175], v[174:175], v[180:181] op_sel_hi:[1,0] neg_lo:[0,1] neg_hi:[0,1]
    v_pk_add_f32 v[176:177], v[176:177], v[168:169]
    v_pk_fma_f32 v[178:179], v[168:169], v[168:169], v[178:179]
    v_pk_add_f32 v[176:177], v[176:177], v[170:171]
    v_pk_fma_f32 v[178:179], v[170:171], v[170:171], v[178:179]
    v_pk_add_f32 v[176:177], v[176:177], v[172:173]
    v_pk_fma_f32 v[178:179], v[172:173], v[172:173], v[178:179]
    v_pk_add_f32 v[176:177], v[176:177], v[174:175]
    v_pk_fma_f32 v[178:179], v[174:175], v[174:175], v[178:179]
    v_add_f32 v176, v176, v177
    v_add_f32 v178, v178, v179
    s_nop 0
    v_add_f32_dpp v176, v176, v176 quad_perm:[1,0,3,2] row_mask:0xf bank_mask:0xf
    v_add_f32_dpp v178, v178, v178 quad_perm:[1,0,3,2] row_mask:0xf bank_mask:0xf
    s_nop 0
    v_add_f32_dpp v176, v176, v176 quad_perm:[2,3,0,1] row_mask:0xf bank_mask:0xf
    v_add_f32_dpp v178, v178, v178 quad_perm:[2,3,0,1] row_mask:0xf bank_mask:0xf
    s_nop 0
    v_add_f32_dpp v176, v176, v176 row_half_mirror row_mask:0xf bank_mask:0xf
    v_add_f32_dpp v178, v178, v178 row_half_mirror row_mask:0xf bank_mask:0xf
    v_mul_f32 v176, 0x3b000000, v176
    v_mul_f32 v178, 0x3b000000, v178
    v_fma_f32 v178, -v176, v176, v178
    v_add_f32 v182, v180, v176
    v_max_f32 v178, 0, v178
    v_cvt_pk_bf16_f32 v178, v178, v178
    v_and_b32 v178, 0xffff0000, v178
    v_add_f32 v178, 0x3727c5ac, v178
    v_cvt_pk_bf16_f32 v178, v178, v178
    v_and_b32 v178, 0xffff0000, v178
    v_sqrt_f32 v178, v178
    v_cvt_pk_bf16_f32 v182, v182, v182
    v_and_b32 v182, 0xffff0000, v182
    v_cvt_pk_bf16_f32 v178, v178, v178
    v_and_b32 v178, 0xffff0000, v178
    v_rcp_f32 v178, v178
    v_sub_f32 v182, v180, v182
    s_lshl_b32 s65, s59, 13
    s_lshl_b32 s66, s93, 12
    s_add_u32 s65, s65, s66
    v_mul_f32 v182, v182, v178
    v_pk_fma_f32 v[136:137], v[136:137], v[178:179], v[182:183] op_sel_hi:[1,0,0]
    v_pk_fma_f32 v[138:139], v[138:139], v[178:179], v[182:183] op_sel_hi:[1,0,0]
    v_pk_fma_f32 v[140:141], v[140:141], v[178:179], v[182:183] op_sel_hi:[1,0,0]
    v_pk_fma_f32 v[142:143], v[142:143], v[178:179], v[182:183] op_sel_hi:[1,0,0]
    v_cvt_pk_bf16_f32 v104, v136, v137
    v_cvt_pk_bf16_f32 v105, v138, v139
    v_cvt_pk_bf16_f32 v106, v140, v141
    v_cvt_pk_bf16_f32 v107, v142, v143
    ds_write_b128 v85, v[104:107] offset:0
    v_pk_fma_f32 v[144:145], v[144:145], v[178:179], v[182:183] op_sel_hi:[1,0,0]
    v_pk_fma_f32 v[146:147], v[146:147], v[178:179], v[182:183] op_sel_hi:[1,0,0]
    v_pk_fma_f32 v[148:149], v[148:149], v[178:179], v[182:183] op_sel_hi:[1,0,0]
    v_pk_fma_f32 v[150:151], v[150:151], v[178:179], v[182:183] op_sel_hi:[1,0,0]
    v_cvt_pk_bf16_f32 v108, v144, v145
    v_cvt_pk_bf16_f32 v109, v146, v147
    v_cvt_pk_bf16_f32 v110, v148, v149
    v_cvt_pk_bf16_f32 v111, v150, v151
    ds_write_b128 v85, v[108:111] offset:128
    v_pk_fma_f32 v[152:153], v[152:153], v[178:179], v[182:183] op_sel_hi:[1,0,0]
    v_pk_fma_f32 v[154:155], v[154:155], v[178:179], v[182:183] op_sel_hi:[1,0,0]
    v_pk_fma_f32 v[156:157], v[156:157], v[178:179], v[182:183] op_sel_hi:[1,0,0]
    v_pk_fma_f32 v[158:159], v[158:159], v[178:179], v[182:183] op_sel_hi:[1,0,0]
    v_cvt_pk_bf16_f32 v112, v152, v153
    v_cvt_pk_bf16_f32 v113, v154, v155
    v_cvt_pk_bf16_f32 v114, v156, v157
    v_cvt_pk_bf16_f32 v115, v158, v159
    ds_write_b128 v85, v[112:115] offset:256
    v_pk_fma_f32 v[160:161], v[160:161], v[178:179], v[182:183] op_sel_hi:[1,0,0]
    v_pk_fma_f32 v[162:163], v[162:163], v[178:179], v[182:183] op_sel_hi:[1,0,0]
    v_pk_fma_f32 v[164:165], v[164:165], v[178:179], v[182:183] op_sel_hi:[1,0,0]
    v_pk_fma_f32 v[166:167], v[166:167], v[178:179], v[182:183] op_sel_hi:[1,0,0]
    v_cvt_pk_bf16_f32 v116, v160, v161
    v_cvt_pk_bf16_f32 v117, v162, v163
    v_cvt_pk_bf16_f32 v118, v164, v165
    v_cvt_pk_bf16_f32 v119, v166, v167
    ds_write_b128 v85, v[116:119] offset:384
    ds_read_b64_tr_b16 v[184:185], v84 offset:0
    ds_read_b64_tr_b16 v[186:187], v84 offset:4224
    ds_read_b64_tr_b16 v[188:189], v84 offset:128
    ds_read_b64_tr_b16 v[190:191], v84 offset:4352
    ds_read_b64_tr_b16 v[192:193], v84 offset:256
    ds_read_b64_tr_b16 v[194:195], v84 offset:4480
    ds_read_b64_tr_b16 v[196:197], v84 offset:384
    ds_read_b64_tr_b16 v[198:199], v84 offset:4608
    s_waitcnt lgkmcnt(6)
    buffer_store_dwordx4 v[184:187], v7, s[32:35], s65 offen offset:0 sc1
    s_waitcnt lgkmcnt(4)
    buffer_store_dwordx4 v[188:191], v7, s[32:35], s65 offen offset:1024 sc1
    s_waitcnt lgkmcnt(2)
    buffer_store_dwordx4 v[192:195], v7, s[32:35], s65 offen offset:2048 sc1
    s_waitcnt lgkmcnt(0)
    buffer_store_dwordx4 v[196:199], v7, s[32:35], s65 offen offset:3072 sc1
    s_waitcnt lgkmcnt(0)
    s_add_u32 s97, s97, 1
    s_waitcnt lgkmcnt(0)
    s_barrier
    ds_read_b64_tr_b16 a[0:1], v20 offset:0
    ds_read_b64_tr_b16 a[2:3], v20 offset:768
    ds_read_b64_tr_b16 a[4:5], v21 offset:0
    ds_read_b64_tr_b16 a[6:7], v21 offset:768
    ds_read_b64_tr_b16 a[8:9], v20 offset:64
    ds_read_b64_tr_b16 a[10:11], v20 offset:832
    ds_read_b64_tr_b16 a[12:13], v21 offset:64
    ds_read_b64_tr_b16 a[14:15], v21 offset:832
    ds_read_b64_tr_b16 a[16:17], v20 offset:128
    ds_read_b64_tr_b16 a[18:19], v20 offset:896
    ds_read_b64_tr_b16 a[20:21], v21 offset:128
    ds_read_b64_tr_b16 a[22:23], v21 offset:896
    ds_read_b64_tr_b16 a[24:25], v20 offset:6144
    ds_read_b64_tr_b16 a[26:27], v20 offset:6912
    ds_read_b64_tr_b16 a[28:29], v21 offset:6144
    ds_read_b64_tr_b16 a[30:31], v21 offset:6912
    ds_read_b64_tr_b16 a[32:33], v20 offset:6208
    ds_read_b64_tr_b16 a[34:35], v20 offset:6976
    ds_read_b64_tr_b16 a[36:37], v21 offset:6208
    ds_read_b64_tr_b16 a[38:39], v21 offset:6976
    ds_read_b64_tr_b16 a[40:41], v20 offset:6272
    ds_read_b64_tr_b16 a[42:43], v20 offset:7040
    ds_read_b64_tr_b16 a[44:45], v21 offset:6272
    ds_read_b64_tr_b16 a[46:47], v21 offset:7040
    s_lshl_b32 s65, s93, 8
    s_add_u32 s65, s65, s59
    s_mul_i32 s65, s65, 64
    s_lshr_b32 s4, s62, 2
    s_lshl_b32 s4, s4, 1
    s_add_u32 s4, s4, s96
    s_lshl_b32 s4, s4, 1
    s_add_u32 s4, s4, s93
    s_mul_i32 s4, s4, 4096
    v_mul_u32_u24 v29, 64, v1
    s_waitcnt vmcnt(0)
    s_atomic_swap s97, s[44:45], s65
    s_xor_b32 s66, s100, 1024
    buffer_store_dwordx4 v[88:91], v26, s[36:39], s100 offen sc1
    buffer_store_dwordx4 v[88:91], v27, s[36:39], s100 offen sc1
    buffer_store_dwordx4 v[88:91], v26, s[36:39], s66 offen sc1
    buffer_store_dwordx4 v[88:91], v27, s[36:39], s66 offen sc1
    s_waitcnt lgkmcnt(0)
    s_barrier
    ds_read_b64_tr_b16 a[48:49], v20 offset:24576
    ds_read_b64_tr_b16 a[50:51], v20 offset:25344
    ds_read_b64_tr_b16 a[52:53], v21 offset:24576
    ds_read_b64_tr_b16 a[54:55], v21 offset:25344
    ds_read_b64_tr_b16 a[56:57], v20 offset:24640
    ds_read_b64_tr_b16 a[58:59], v20 offset:25408
    ds_read_b64_tr_b16 a[60:61], v21 offset:24640
    ds_read_b64_tr_b16 a[62:63], v21 offset:25408
    ds_read_b64_tr_b16 a[64:65], v20 offset:24704
    ds_read_b64_tr_b16 a[66:67], v20 offset:25472
    ds_read_b64_tr_b16 a[68:69], v21 offset:24704
    ds_read_b64_tr_b16 a[70:71], v21 offset:25472
    ds_read_b64_tr_b16 a[72:73], v20 offset:30720
    ds_read_b64_tr_b16 a[74:75], v20 offset:31488
    ds_read_b64_tr_b16 a[76:77], v21 offset:30720
    ds_read_b64_tr_b16 a[78:79], v21 offset:31488
    ds_read_b64_tr_b16 a[80:81], v20 offset:30784
    ds_read_b64_tr_b16 a[82:83], v20 offset:31552
    ds_read_b64_tr_b16 a[84:85], v21 offset:30784
    ds_read_b64_tr_b16 a[86:87], v21 offset:31552
    ds_read_b64_tr_b16 a[88:89], v20 offset:30848
    ds_read_b64_tr_b16 a[90:91], v20 offset:31616
    ds_read_b64_tr_b16 a[92:93], v21 offset:30848
    ds_read_b64_tr_b16 a[94:95], v21 offset:31616
    ds_read_b64_tr_b16 a[96:97], v22 offset:0
    ds_read_b64_tr_b16 a[98:99], v22 offset:768
    ds_read_b64_tr_b16 a[100:101], v23 offset:0
    ds_read_b64_tr_b16 a[102:103], v23 offset:768
    ds_read_b64_tr_b16 a[104:105], v22 offset:64
    ds_read_b64_tr_b16 a[106:107], v22 offset:832
    ds_read_b64_tr_b16 a[108:109], v23 offset:64
    ds_read_b64_tr_b16 a[110:111], v23 offset:832
    ds_read_b64_tr_b16 a[112:113], v22 offset:128
    ds_read_b64_tr_b16 a[114:115], v22 offset:896
    ds_read_b64_tr_b16 a[116:117], v23 offset:128
    ds_read_b64_tr_b16 a[118:119], v23 offset:896
    ds_read_b64_tr_b16 a[120:121], v22 offset:6144
    ds_read_b64_tr_b16 a[122:123], v22 offset:6912
    ds_read_b64_tr_b16 a[124:125], v23 offset:6144
    ds_read_b64_tr_b16 a[126:127], v23 offset:6912
    ds_read_b64_tr_b16 a[128:129], v22 offset:6208
    ds_read_b64_tr_b16 a[130:131], v22 offset:6976
    ds_read_b64_tr_b16 a[132:133], v23 offset:6208
    ds_read_b64_tr_b16 a[134:135], v23 offset:6976
    ds_read_b64_tr_b16 a[136:137], v22 offset:6272
    ds_read_b64_tr_b16 a[138:139], v22 offset:7040
    ds_read_b64_tr_b16 a[140:141], v23 offset:6272
    ds_read_b64_tr_b16 a[142:143], v23 offset:7040
    buffer_load_dword v28, v29, s[44:47], s4 offen sc1
    s_waitcnt vmcnt(0)
    v_cmp_ne_u32 vcc, s97, v28
    s_cbranch_vccnz L_fretry0
L_fok0:
    s_waitcnt lgkmcnt(0)
    s_barrier
    s_waitcnt lgkmcnt(0)
    s_branch L_join
L_ldpath:
    s_add_u32 m0, s73, 24576
    s_add_u32 s98, s67, 0
    buffer_load_dwordx4 v4, s[24:27], s98 offen offset:0 lds
    buffer_load_dwordx4 v5, s[24:27], s98 offen offset:1024 lds
    buffer_load_dwordx4 v6, s[24:27], s98 offen offset:2048 lds
    s_add_u32 m0, s73, 27648
    s_add_u32 s98, s67, 44032
    buffer_load_dwordx4 v4, s[24:27], s98 offen offset:0 lds
    buffer_load_dwordx4 v5, s[24:27], s98 offen offset:1024 lds
    buffer_load_dwordx4 v6, s[24:27], s98 offen offset:2048 lds
    s_add_u32 m0, s73, 30720
    s_add_u32 s98, s67, 88064
    buffer_load_dwordx4 v4, s[24:27], s98 offen offset:0 lds
    buffer_load_dwordx4 v5, s[24:27], s98 offen offset:1024 lds
    buffer_load_dwordx4 v6, s[24:27], s98 offen offset:2048 lds
    s_add_u32 m0, s73, 33792
    s_add_u32 s98, s67, 132096
    buffer_load_dwordx4 v4, s[24:27], s98 offen offset:0 lds
    buffer_load_dwordx4 v5, s[24:27], s98 offen offset:1024 lds
    buffer_load_dwordx4 v6, s[24:27], s98 offen offset:2048 lds
    s_add_u32 s67, s67, 352256
    s_cmp_ge_u32 s67, s69
    s_cselect_b32 s67, s68, s67
    s_add_u32 m0, s73, 49152
    s_add_u32 s98, s67, 0
    buffer_load_dwordx4 v4, s[24:27], s98 offen offset:0 lds
    buffer_load_dwordx4 v5, s[24:27], s98 offen offset:1024 lds
    buffer_load_dwordx4 v6, s[24:27], s98 offen offset:2048 lds
    s_add_u32 m0, s73, 52224
    s_add_u32 s98, s67, 44032
    buffer_load_dwordx4 v4, s[24:27], s98 offen offset:0 lds
    buffer_load_dwordx4 v5, s[24:27], s98 offen offset:1024 lds
    buffer_load_dwordx4 v6, s[24:27], s98 offen offset:2048 lds
    s_add_u32 m0, s73, 55296
    s_add_u32 s98, s67, 88064
    buffer_load_dwordx4 v4, s[24:27], s98 offen offset:0 lds
    buffer_load_dwordx4 v5, s[24:27], s98 offen offset:1024 lds
    buffer_load_dwordx4 v6, s[24:27], s98 offen offset:2048 lds
    s_add_u32 m0, s73, 58368
    s_add_u32 s98, s67, 132096
    buffer_load_dwordx4 v4, s[24:27], s98 offen offset:0 lds
    buffer_load_dwordx4 v5, s[24:27], s98 offen offset:1024 lds
    buffer_load_dwordx4 v6, s[24:27], s98 offen offset:2048 lds
    s_add_u32 s67, s67, 352256
    s_cmp_ge_u32 s67, s69
    s_cselect_b32 s67, s68, s67
    s_waitcnt lgkmcnt(0)
    s_add_u32 s97, s97, 1
    s_waitcnt vmcnt(24)
    s_waitcnt lgkmcnt(0)
    s_barrier
    s_add_u32 m0, s73, 73728
    s_add_u32 s98, s67, 0
    buffer_load_dwordx4 v4, s[24:27], s98 offen offset:0 lds
    buffer_load_dwordx4 v5, s[24:27], s98 offen offset:1024 lds
    buffer_load_dwordx4 v6, s[24:27], s98 offen offset:2048 lds
    s_add_u32 m0, s73, 76800
    s_add_u32 s98, s67, 44032
    buffer_load_dwordx4 v4, s[24:27], s98 offen offset:0 lds
    buffer_load_dwordx4 v5, s[24:27], s98 offen offset:1024 lds
    buffer_load_dwordx4 v6, s[24:27], s98 offen offset:2048 lds
    s_add_u32 m0, s73, 79872
    s_add_u32 s98, s67, 88064
    buffer_load_dwordx4 v4, s[24:27], s98 offen offset:0 lds
    buffer_load_dwordx4 v5, s[24:27], s98 offen offset:1024 lds
    buffer_load_dwordx4 v6, s[24:27], s98 offen offset:2048 lds
    s_add_u32 m0, s73, 82944
    s_add_u32 s98, s67, 132096
    buffer_load_dwordx4 v4, s[24:27], s98 offen offset:0 lds
    buffer_load_dwordx4 v5, s[24:27], s98 offen offset:1024 lds
    buffer_load_dwordx4 v6, s[24:27], s98 offen offset:2048 lds
    s_add_u32 s67, s67, 352256
    s_cmp_ge_u32 s67, s69
    s_cselect_b32 s67, s68, s67
    ds_read_b64_tr_b16 a[0:1], v20 offset:0
    ds_read_b64_tr_b16 a[2:3], v20 offset:768
    ds_read_b64_tr_b16 a[4:5], v21 offset:0
    ds_read_b64_tr_b16 a[6:7], v21 offset:768
    ds_read_b64_tr_b16 a[8:9], v20 offset:64
    ds_read_b64_tr_b16 a[10:11], v20 offset:832
    ds_read_b64_tr_b16 a[12:13], v21 offset:64
    ds_read_b64_tr_b16 a[14:15], v21 offset:832
    ds_read_b64_tr_b16 a[16:17], v20 offset:128
    ds_read_b64_tr_b16 a[18:19], v20 offset:896
    ds_read_b64_tr_b16 a[20:21], v21 offset:128
    ds_read_b64_tr_b16 a[22:23], v21 offset:896
    ds_read_b64_tr_b16 a[24:25], v20 offset:6144
    ds_read_b64_tr_b16 a[26:27], v20 offset:6912
    ds_read_b64_tr_b16 a[28:29], v21 offset:6144
    ds_read_b64_tr_b16 a[30:31], v21 offset:6912
    ds_read_b64_tr_b16 a[32:33], v20 offset:6208
    ds_read_b64_tr_b16 a[34:35], v20 offset:6976
    ds_read_b64_tr_b16 a[36:37], v21 offset:6208
    ds_read_b64_tr_b16 a[38:39], v21 offset:6976
    ds_read_b64_tr_b16 a[40:41], v20 offset:6272
    ds_read_b64_tr_b16 a[42:43], v20 offset:7040
    ds_read_b64_tr_b16 a[44:45], v21 offset:6272
    ds_read_b64_tr_b16 a[46:47], v21 offset:7040
    s_add_u32 m0, s73, 98304
    s_add_u32 s98, s67, 0
    buffer_load_dwordx4 v4, s[24:27], s98 offen offset:0 lds
    buffer_load_dwordx4 v5, s[24:27], s98 offen offset:1024 lds
    buffer_load_dwordx4 v6, s[24:27], s98 offen offset:2048 lds
    s_add_u32 m0, s73, 101376
    s_add_u32 s98, s67, 44032
    buffer_load_dwordx4 v4, s[24:27], s98 offen offset:0 lds
    buffer_load_dwordx4 v5, s[24:27], s98 offen offset:1024 lds
    buffer_load_dwordx4 v6, s[24:27], s98 offen offset:2048 lds
    s_add_u32 m0, s73, 104448
    s_add_u32 s98, s67, 88064
    buffer_load_dwordx4 v4, s[24:27], s98 offen offset:0 lds
    buffer_load_dwordx4 v5, s[24:27], s98 offen offset:1024 lds
    buffer_load_dwordx4 v6, s[24:27], s98 offen offset:2048 lds
    s_add_u32 m0, s73, 107520
    s_add_u32 s98, s67, 132096
    buffer_load_dwordx4 v4, s[24:27], s98 offen offset:0 lds
    buffer_load_dwordx4 v5, s[24:27], s98 offen offset:1024 lds
    buffer_load_dwordx4 v6, s[24:27], s98 offen offset:2048 lds
    s_add_u32 s67, s67, 352256
    s_cmp_ge_u32 s67, s69
    s_cselect_b32 s67, s68, s67
    s_waitcnt vmcnt(36)
    s_waitcnt vmcnt(24)
    s_waitcnt lgkmcnt(0)
    s_barrier
    s_add_u32 m0, s73, 122880
    s_add_u32 s98, s67, 0
    buffer_load_dwordx4 v4, s[24:27], s98 offen offset:0 lds
    buffer_load_dwordx4 v5, s[24:27], s98 offen offset:1024 lds
    buffer_load_dwordx4 v6, s[24:27], s98 offen offset:2048 lds
    s_add_u32 m0, s73, 125952
    s_add_u32 s98, s67, 44032
    buffer_load_dwordx4 v4, s[24:27], s98 offen offset:0 lds
    buffer_load_dwordx4 v5, s[24:27], s98 offen offset:1024 lds
    buffer_load_dwordx4 v6, s[24:27], s98 offen offset:2048 lds
    s_add_u32 m0, s73, 129024
    s_add_u32 s98, s67, 88064
    buffer_load_dwordx4 v4, s[24:27], s98 offen offset:0 lds
    buffer_load_dwordx4 v5, s[24:27], s98 offen offset:1024 lds
    buffer_load_dwordx4 v6, s[24:27], s98 offen offset:2048 lds
    s_add_u32 m0, s73, 132096
    s_add_u32 s98, s67, 132096
    buffer_load_dwordx4 v4, s[24:27], s98 offen offset:0 lds
    buffer_load_dwordx4 v5, s[24:27], s98 offen offset:1024 lds
    buffer_load_dwordx4 v6, s[24:27], s98 offen offset:2048 lds
    s_add_u32 s67, s67, 352256
    s_cmp_ge_u32 s67, s69
    s_cselect_b32 s67, s68, s67
    ds_read_b64_tr_b16 a[48:49], v20 offset:24576
    ds_read_b64_tr_b16 a[50:51], v20 offset:25344
    ds_read_b64_tr_b16 a[52:53], v21 offset:24576
    ds_read_b64_tr_b16 a[54:55], v21 offset:25344
    ds_read_b64_tr_b16 a[56:57], v20 offset:24640
    ds_read_b64_tr_b16 a[58:59], v20 offset:25408
    ds_read_b64_tr_b16 a[60:61], v21 offset:24640
    ds_read_b64_tr_b16 a[62:63], v21 offset:25408
    ds_read_b64_tr_b16 a[64:65], v20 offset:24704
    ds_read_b64_tr_b16 a[66:67], v20 offset:25472
    ds_read_b64_tr_b16 a[68:69], v21 offset:24704
    ds_read_b64_tr_b16 a[70:71], v21 offset:25472
    ds_read_b64_tr_b16 a[72:73], v20 offset:30720
    ds_read_b64_tr_b16 a[74:75], v20 offset:31488
    ds_read_b64_tr_b16 a[76:77], v21 offset:30720
    ds_read_b64_tr_b16 a[78:79], v21 offset:31488
    ds_read_b64_tr_b16 a[80:81], v20 offset:30784
    ds_read_b64_tr_b16 a[82:83], v20 offset:31552
    ds_read_b64_tr_b16 a[84:85], v21 offset:30784
    ds_read_b64_tr_b16 a[86:87], v21 offset:31552
    ds_read_b64_tr_b16 a[88:89], v20 offset:30848
    ds_read_b64_tr_b16 a[90:91], v20 offset:31616
    ds_read_b64_tr_b16 a[92:93], v21 offset:30848
    ds_read_b64_tr_b16 a[94:95], v21 offset:31616
    ds_read_b64_tr_b16 a[96:97], v22 offset:0
    ds_read_b64_tr_b16 a[98:99], v22 offset:768
    ds_read_b64_tr_b16 a[100:101], v23 offset:0
    ds_read_b64_tr_b16 a[102:103], v23 offset:768
    ds_read_b64_tr_b16 a[104:105], v22 offset:64
    ds_read_b64_tr_b16 a[106:107], v22 offset:832
    ds_read_b64_tr_b16 a[108:109], v23 offset:64
    ds_read_b64_tr_b16 a[110:111], v23 offset:832
    ds_read_b64_tr_b16 a[112:113], v22 offset:128
    ds_read_b64_tr_b16 a[114:115], v22 offset:896
    ds_read_b64_tr_b16 a[116:117], v23 offset:128
    ds_read_b64_tr_b16 a[118:119], v23 offset:896
    ds_read_b64_tr_b16 a[120:121], v22 offset:6144
    ds_read_b64_tr_b16 a[122:123], v22 offset:6912
    ds_read_b64_tr_b16 a[124:125], v23 offset:6144
    ds_read_b64_tr_b16 a[126:127], v23 offset:6912
    ds_read_b64_tr_b16 a[128:129], v22 offset:6208
    ds_read_b64_tr_b16 a[130:131], v22 offset:6976
    ds_read_b64_tr_b16 a[132:133], v23 offset:6208
    ds_read_b64_tr_b16 a[134:135], v23 offset:6976
    ds_read_b64_tr_b16 a[136:137], v22 offset:6272
    ds_read_b64_tr_b16 a[138:139], v22 offset:7040
    ds_read_b64_tr_b16 a[140:141], v23 offset:6272
    ds_read_b64_tr_b16 a[142:143], v23 offset:7040
    s_add_u32 m0, s73, 0
    s_add_u32 s98, s67, 0
    buffer_load_dwordx4 v4, s[24:27], s98 offen offset:0 lds
    buffer_load_dwordx4 v5, s[24:27], s98 offen offset:1024 lds
    buffer_load_dwordx4 v6, s[24:27], s98 offen offset:2048 lds
    s_add_u32 m0, s73, 3072
    s_add_u32 s98, s67, 44032
    buffer_load_dwordx4 v4, s[24:27], s98 offen offset:0 lds
    buffer_load_dwordx4 v5, s[24:27], s98 offen offset:1024 lds
    buffer_load_dwordx4 v6, s[24:27], s98 offen offset:2048 lds
    s_add_u32 m0, s73, 6144
    s_add_u32 s98, s67, 88064
    buffer_load_dwordx4 v4, s[24:27], s98 offen offset:0 lds
    buffer_load_dwordx4 v5, s[24:27], s98 offen offset:1024 lds
    buffer_load_dwordx4 v6, s[24:27], s98 offen offset:2048 lds
    s_add_u32 m0, s73, 9216
    s_add_u32 s98, s67, 132096
    buffer_load_dwordx4 v4, s[24:27], s98 offen offset:0 lds
    buffer_load_dwordx4 v5, s[24:27], s98 offen offset:1024 lds
    buffer_load_dwordx4 v6, s[24:27], s98 offen offset:2048 lds
    s_add_u32 s67, s67, 352256
    s_cmp_ge_u32 s67, s69
    s_cselect_b32 s67, s68, s67
    s_waitcnt vmcnt(36)
    s_waitcnt vmcnt(24)
    s_waitcnt lgkmcnt(0)
    s_barrier
    s_add_u32 m0, s73, 24576
    s_add_u32 s98, s67, 0
    buffer_load_dwordx4 v4, s[24:27], s98 offen offset:0 lds
    buffer_load_dwordx4 v5, s[24:27], s98 offen offset:1024 lds
    buffer_load_dwordx4 v6, s[24:27], s98 offen offset:2048 lds
    s_add_u32 m0, s73, 27648
    s_add_u32 s98, s67, 44032
    buffer_load_dwordx4 v4, s[24:27], s98 offen offset:0 lds
    buffer_load_dwordx4 v5, s[24:27], s98 offen offset:1024 lds
    buffer_load_dwordx4 v6, s[24:27], s98 offen offset:2048 lds
    s_add_u32 m0, s73, 30720
    s_add_u32 s98, s67, 88064
    buffer_load_dwordx4 v4, s[24:27], s98 offen offset:0 lds
    buffer_load_dwordx4 v5, s[24:27], s98 offen offset:1024 lds
    buffer_load_dwordx4 v6, s[24:27], s98 offen offset:2048 lds
    s_add_u32 m0, s73, 33792
    s_add_u32 s98, s67, 132096
    buffer_load_dwordx4 v4, s[24:27], s98 offen offset:0 lds
    buffer_load_dwordx4 v5, s[24:27], s98 offen offset:1024 lds
    buffer_load_dwordx4 v6, s[24:27], s98 offen offset:2048 lds
    s_add_u32 s67, s67, 352256
    s_cmp_ge_u32 s67, s69
    s_cselect_b32 s67, s68, s67
    s_waitcnt lgkmcnt(0)
L_join:
    buffer_load_dwordx4 v[104:107], v12, s[32:35], s70 offen sc1
    buffer_load_dwordx4 v[108:111], v13, s[32:35], s70 offen sc1
    buffer_load_dwordx4 v[112:115], v14, s[32:35], s70 offen sc1
    buffer_load_dwordx4 v[116:119], v15, s[32:35], s70 offen sc1
    s_add_u32 s70, s70, 131072
    s_cmp_ge_u32 s70, s72
    s_cselect_b32 s70, s71, s70
    buffer_load_dwordx4 v[120:123], v12, s[32:35], s70 offen sc1
    buffer_load_dwordx4 v[124:127], v13, s[32:35], s70 offen sc1
    buffer_load_dwordx4 v[128:131], v14, s[32:35], s70 offen sc1
    buffer_load_dwordx4 v[132:135], v15, s[32:35], s70 offen sc1
    s_add_u32 s70, s70, 131072
    s_cmp_ge_u32 s70, s72
    s_cselect_b32 s70, s71, s70
    s_add_u32 s65, s2, 512
    s_mul_i32 s65, s65, 64
    s_cmp_lg_u32 s60, 0
    s_cbranch_scc1 L_nopub2
    s_atomic_swap s97, s[44:45], s65
L_nopub2:
    v_lshlrev_b32 v30, 3, v3
    s_lshl_b32 s65, s99, 5
    buffer_load_dwordx2 v[244:245], v30, s[48:51], s65 offen offset:0
    buffer_load_dwordx2 v[246:247], v30, s[48:51], s65 offen offset:32
    buffer_load_dwordx2 v[248:249], v30, s[48:51], s65 offen offset:64
    ds_read_b64_tr_b16 a[144:145], v22 offset:24576
    ds_read_b64_tr_b16 a[146:147], v22 offset:25344
    ds_read_b64_tr_b16 a[148:149], v23 offset:24576
    ds_read_b64_tr_b16 a[150:151], v23 offset:25344
    ds_read_b64_tr_b16 a[152:153], v22 offset:24640
    ds_read_b64_tr_b16 a[154:155], v22 offset:25408
    ds_read_b64_tr_b16 a[156:157], v23 offset:24640
    ds_read_b64_tr_b16 a[158:159], v23 offset:25408
    ds_read_b64_tr_b16 a[160:161], v22 offset:24704
    ds_read_b64_tr_b16 a[162:163], v22 offset:25472
    ds_read_b64_tr_b16 a[164:165], v23 offset:24704
    ds_read_b64_tr_b16 a[166:167], v23 offset:25472
    ds_read_b64_tr_b16 a[168:169], v22 offset:30720
    ds_read_b64_tr_b16 a[170:171], v22 offset:31488
    ds_read_b64_tr_b16 a[172:173], v23 offset:30720
    ds_read_b64_tr_b16 a[174:175], v23 offset:31488
    ds_read_b64_tr_b16 a[176:177], v22 offset:30784
    ds_read_b64_tr_b16 a[178:179], v22 offset:31552
    ds_read_b64_tr_b16 a[180:181], v23 offset:30784
    ds_read_b64_tr_b16 a[182:183], v23 offset:31552
    ds_read_b64_tr_b16 a[184:185], v22 offset:30848
    ds_read_b64_tr_b16 a[186:187], v22 offset:31616
    ds_read_b64_tr_b16 a[188:189], v23 offset:30848
    ds_read_b64_tr_b16 a[190:191], v23 offset:31616
    buffer_load_dwordx4 v[136:139], v12, s[32:35], s70 offen sc1
    buffer_load_dwordx4 v[140:143], v13, s[32:35], s70 offen sc1
    buffer_load_dwordx4 v[144:147], v14, s[32:35], s70 offen sc1
    buffer_load_dwordx4 v[148:151], v15, s[32:35], s70 offen sc1
    s_add_u32 s70, s70, 131072
    s_cmp_ge_u32 s70, s72
    s_cselect_b32 s70, s71, s70
    ds_read_b64_tr_b16 a[192:193], v24 offset:0
    ds_read_b64_tr_b16 a[194:195], v24 offset:768
    ds_read_b64_tr_b16 a[196:197], v25 offset:0
    ds_read_b64_tr_b16 a[198:199], v25 offset:768
    ds_read_b64_tr_b16 a[200:201], v24 offset:64
    ds_read_b64_tr_b16 a[202:203], v24 offset:832
    ds_read_b64_tr_b16 a[204:205], v25 offset:64
    ds_read_b64_tr_b16 a[206:207], v25 offset:832
    ds_read_b64_tr_b16 a[208:209], v24 offset:128
    ds_read_b64_tr_b16 a[210:211], v24 offset:896
    ds_read_b64_tr_b16 a[212:213], v25 offset:128
    ds_read_b64_tr_b16 a[214:215], v25 offset:896
    ds_read_b64_tr_b16 a[216:217], v24 offset:6144
    ds_read_b64_tr_b16 a[218:219], v24 offset:6912
    ds_read_b64_tr_b16 a[220:221], v25 offset:6144
    ds_read_b64_tr_b16 a[222:223], v25 offset:6912
    ds_read_b64_tr_b16 a[224:225], v24 offset:6208
    ds_read_b64_tr_b16 a[226:227], v24 offset:6976
    ds_read_b64_tr_b16 a[228:229], v25 offset:6208
    ds_read_b64_tr_b16 a[230:231], v25 offset:6976
    ds_read_b64_tr_b16 a[232:233], v24 offset:6272
    ds_read_b64_tr_b16 a[234:235], v24 offset:7040
    ds_read_b64_tr_b16 a[236:237], v25 offset:6272
    ds_read_b64_tr_b16 a[238:239], v25 offset:7040
    s_waitcnt lgkmcnt(0)
    s_waitcnt vmcnt(13)
    v_mfma_f32_16x16x32_bf16 v[68:71], a[12:15], v[108:111], v[68:71]
    buffer_load_dwordx4 v[152:155], v12, s[32:35], s70 offen sc1
    v_mfma_f32_16x16x32_bf16 v[44:47], a[12:15], v[104:107], v[44:47]
    v_mfma_f32_16x16x32_bf16 v[72:75], a[16:19], v[108:111], v[72:75]
    v_mfma_f32_16x16x32_bf16 v[48:51], a[16:19], v[104:107], v[48:51]
    buffer_load_dwordx4 v[156:159], v13, s[32:35], s70 offen sc1
    v_mfma_f32_16x16x32_bf16 v[76:79], a[20:23], v[108:111], v[76:79]
    v_mfma_f32_16x16x32_bf16 v[52:55], a[20:23], v[104:107], v[52:55]
    v_mfma_f32_16x16x32_bf16 v[56:59], a[0:3], v[108:111], v[56:59]
    buffer_load_dwordx4 v[160:163], v14, s[32:35], s70 offen sc1
    v_mfma_f32_16x16x32_bf16 v[32:35], a[0:3], v[104:107], v[32:35]
    v_mfma_f32_16x16x32_bf16 v[60:63], a[4:7], v[108:111], v[60:63]
    v_mfma_f32_16x16x32_bf16 v[36:39], a[4:7], v[104:107], v[36:39]
    buffer_load_dwordx4 v[164:167], v15, s[32:35], s70 offen sc1
    s_add_u32 s70, s70, 131072
    s_cmp_ge_u32 s70, s72
    s_cselect_b32 s70, s71, s70
    v_mfma_f32_16x16x32_bf16 v[64:67], a[8:11], v[108:111], v[64:67]
    v_mfma_f32_16x16x32_bf16 v[40:43], a[8:11], v[104:107], v[40:43]
    s_waitcnt vmcnt(15)
    v_mfma_f32_16x16x32_bf16 v[68:71], a[36:39], v[116:119], v[68:71]
    buffer_load_dwordx4 v[168:171], v12, s[32:35], s70 offen sc1
    v_mfma_f32_16x16x32_bf16 v[44:47], a[36:39], v[112:115], v[44:47]
    v_mfma_f32_16x16x32_bf16 v[72:75], a[40:43], v[116:119], v[72:75]
    v_mfma_f32_16x16x32_bf16 v[48:51], a[40:43], v[112:115], v[48:51]
    buffer_load_dwordx4 v[172:175], v13, s[32:35], s70 offen sc1
    v_mfma_f32_16x16x32_bf16 v[76:79], a[44:47], v[116:119], v[76:79]
    v_mfma_f32_16x16x32_bf16 v[52:55], a[44:47], v[112:115], v[52:55]
    v_mfma_f32_16x16x32_bf16 v[56:59], a[24:27], v[116:119], v[56:59]
    buffer_load_dwordx4 v[176:179], v14, s[32:35], s70 offen sc1
    v_mfma_f32_16x16x32_bf16 v[32:35], a[24:27], v[112:115], v[32:35]
    v_mfma_f32_16x16x32_bf16 v[60:63], a[28:31], v[116:119], v[60:63]
    v_mfma_f32_16x16x32_bf16 v[36:39], a[28:31], v[112:115], v[36:39]
    buffer_load_dwordx4 v[180:183], v15, s[32:35], s70 offen sc1
    s_add_u32 s70, s70, 131072
    s_cmp_ge_u32 s70, s72
    s_cselect_b32 s70, s71, s70
    v_mfma_f32_16x16x32_bf16 v[64:67], a[32:35], v[116:119], v[64:67]
    v_mfma_f32_16x16x32_bf16 v[40:43], a[32:35], v[112:115], v[40:43]
    s_waitcnt vmcnt(17)
    v_mfma_f32_16x16x32_bf16 v[68:71], a[60:63], v[124:127], v[68:71]
    buffer_load_dwordx4 v[184:187], v12, s[32:35], s70 offen sc1
    v_mfma_f32_16x16x32_bf16 v[44:47], a[60:63], v[120:123], v[44:47]
    v_mfma_f32_16x16x32_bf16 v[72:75], a[64:67], v[124:127], v[72:75]
    v_mfma_f32_16x16x32_bf16 v[48:51], a[64:67], v[120:123], v[48:51]
    buffer_load_dwordx4 v[188:191], v13, s[32:35], s70 offen sc1
    v_mfma_f32_16x16x32_bf16 v[76:79], a[68:71], v[124:127], v[76:79]
    v_mfma_f32_16x16x32_bf16 v[52:55], a[68:71], v[120:123], v[52:55]
    s_waitcnt vmcnt(17)
    v_mfma_f32_16x16x32_bf16 v[68:71], a[84:87], v[132:135], v[68:71]
    buffer_load_dwordx4 v[192:195], v14, s[32:35], s70 offen sc1
    v_mfma_f32_16x16x32_bf16 v[44:47], a[84:87], v[128:131], v[44:47]
    v_mfma_f32_16x16x32_bf16 v[72:75], a[88:91], v[132:135], v[72:75]
    v_mfma_f32_16x16x32_bf16 v[48:51], a[88:91], v[128:131], v[48:51]
    buffer_load_dwordx4 v[196:199], v15, s[32:35], s70 offen sc1
    s_add_u32 s70, s70, 131072
    s_cmp_ge_u32 s70, s72
    s_cselect_b32 s70, s71, s70
    v_mfma_f32_16x16x32_bf16 v[76:79], a[92:95], v[132:135], v[76:79]
    v_mfma_f32_16x16x32_bf16 v[52:55], a[92:95], v[128:131], v[52:55]
    s_waitcnt vmcnt(14)
    v_mfma_f32_16x16x32_bf16 v[68:71], a[108:111], v[140:143], v[68:71]
    buffer_load_dwordx4 v[200:203], v12, s[32:35], s70 offen sc1
    v_mfma_f32_16x16x32_bf16 v[44:47], a[108:111], v[136:139], v[44:47]
    v_mfma_f32_16x16x32_bf16 v[72:75], a[112:115], v[140:143], v[72:75]
    v_mfma_f32_16x16x32_bf16 v[48:51], a[112:115], v[136:139], v[48:51]
    buffer_load_dwordx4 v[204:207], v13, s[32:35], s70 offen sc1
    v_mfma_f32_16x16x32_bf16 v[76:79], a[116:119], v[140:143], v[76:79]
    v_mfma_f32_16x16x32_bf16 v[52:55], a[116:119], v[136:139], v[52:55]
    s_waitcnt vmcnt(14)
    v_mfma_f32_16x16x32_bf16 v[68:71], a[132:135], v[148:151], v[68:71]
    buffer_load_dwordx4 v[208:211], v14, s[32:35], s70 offen sc1
    v_mfma_f32_16x16x32_bf16 v[44:47], a[132:135], v[144:147], v[44:47]
    v_mfma_f32_16x16x32_bf16 v[72:75], a[136:139], v[148:151], v[72:75]
    v_mfma_f32_16x16x32_bf16 v[48:51], a[136:139], v[144:147], v[48:51]
    buffer_load_dwordx4 v[212:215], v15, s[32:35], s70 offen sc1
    s_add_u32 s70, s70, 131072
    s_cmp_ge_u32 s70, s72
    s_cselect_b32 s70, s71, s70
    v_mfma_f32_16x16x32_bf16 v[76:79], a[140:143], v[148:151], v[76:79]
    v_mfma_f32_16x16x32_bf16 v[52:55], a[140:143], v[144:147], v[52:55]
    s_waitcnt vmcnt(14)
    v_mfma_f32_16x16x32_bf16 v[68:71], a[156:159], v[156:159], v[68:71]
    buffer_load_dwordx4 v[216:219], v12, s[32:35], s70 offen sc1
    v_mfma_f32_16x16x32_bf16 v[44:47], a[156:159], v[152:155], v[44:47]
    v_mfma_f32_16x16x32_bf16 v[72:75], a[160:163], v[156:159], v[72:75]
    v_mfma_f32_16x16x32_bf16 v[48:51], a[160:163], v[152:155], v[48:51]
    buffer_load_dwordx4 v[220:223], v13, s[32:35], s70 offen sc1
    v_mfma_f32_16x16x32_bf16 v[76:79], a[164:167], v[156:159], v[76:79]
    v_mfma_f32_16x16x32_bf16 v[52:55], a[164:167], v[152:155], v[52:55]
    s_waitcnt vmcnt(14)
    v_mfma_f32_16x16x32_bf16 v[68:71], a[180:183], v[164:167], v[68:71]
    buffer_load_dwordx4 v[224:227], v14, s[32:35], s70 offen sc1
    v_mfma_f32_16x16x32_bf16 v[44:47], a[180:183], v[160:163], v[44:47]
    v_mfma_f32_16x16x32_bf16 v[72:75], a[184:187], v[164:167], v[72:75]
    v_mfma_f32_16x16x32_bf16 v[48:51], a[184:187], v[160:163], v[48:51]
    buffer_load_dwordx4 v[228:231], v15, s[32:35], s70 offen sc1
    s_add_u32 s70, s70, 131072
    s_cmp_ge_u32 s70, s72
    s_cselect_b32 s70, s71, s70
    v_mfma_f32_16x16x32_bf16 v[76:79], a[188:191], v[164:167], v[76:79]
    v_mfma_f32_16x16x32_bf16 v[52:55], a[188:191], v[160:163], v[52:55]
    s_waitcnt lgkmcnt(0)
    s_barrier
    ds_read_b64_tr_b16 v[80:81], v25 offset:24640
    ds_read_b64_tr_b16 v[82:83], v25 offset:25408
    ds_read_b64_tr_b16 v[84:85], v24 offset:24704
    ds_read_b64_tr_b16 v[86:87], v24 offset:25472
    ds_read_b64_tr_b16 v[88:89], v25 offset:24704
    ds_read_b64_tr_b16 v[90:91], v25 offset:25472
    ds_read_b64_tr_b16 v[92:93], v25 offset:30784
    ds_read_b64_tr_b16 v[94:95], v25 offset:31552
    ds_read_b64_tr_b16 v[96:97], v24 offset:30848
    ds_read_b64_tr_b16 v[98:99], v24 offset:31616
    s_waitcnt vmcnt(14)
    v_mfma_f32_16x16x32_bf16 v[68:71], a[204:207], v[172:175], v[68:71]
    v_mfma_f32_16x16x32_bf16 v[44:47], a[204:207], v[168:171], v[44:47]
    v_mfma_f32_16x16x32_bf16 v[72:75], a[208:211], v[172:175], v[72:75]
    v_mfma_f32_16x16x32_bf16 v[48:51], a[208:211], v[168:171], v[48:51]
    s_add_u32 m0, s5, 147456
    s_nop 0
    buffer_load_dwordx4 v8, s[28:31], s56 offen offset:0 lds
    v_mfma_f32_16x16x32_bf16 v[76:79], a[212:215], v[172:175], v[76:79]
    v_mfma_f32_16x16x32_bf16 v[52:55], a[212:215], v[168:171], v[52:55]
    s_waitcnt vmcnt(13)
    v_mfma_f32_16x16x32_bf16 v[68:71], a[228:231], v[180:183], v[68:71]
    v_mfma_f32_16x16x32_bf16 v[44:47], a[228:231], v[176:179], v[44:47]
    buffer_load_dwordx4 v9, s[28:31], s56 offen offset:1024 lds
    v_mfma_f32_16x16x32_bf16 v[72:75], a[232:235], v[180:183], v[72:75]
    v_mfma_f32_16x16x32_bf16 v[48:51], a[232:235], v[176:179], v[48:51]
    v_mfma_f32_16x16x32_bf16 v[76:79], a[236:239], v[180:183], v[76:79]
    v_mfma_f32_16x16x32_bf16 v[52:55], a[236:239], v[176:179], v[52:55]
    buffer_load_dwordx4 v10, s[28:31], s56 offen offset:2048 lds
    s_waitcnt vmcnt(13)
    s_waitcnt lgkmcnt(8)
    v_mfma_f32_16x16x32_bf16 v[68:71], v[80:83], v[188:191], v[68:71]
    v_mfma_f32_16x16x32_bf16 v[44:47], v[80:83], v[184:187], v[44:47]
    ds_read_b64_tr_b16 v[100:101], v25 offset:30848
    ds_read_b64_tr_b16 v[102:103], v25 offset:31616
    s_waitcnt lgkmcnt(8)
    v_mfma_f32_16x16x32_bf16 v[72:75], v[84:87], v[188:191], v[72:75]
    v_mfma_f32_16x16x32_bf16 v[48:51], v[84:87], v[184:187], v[48:51]
    buffer_load_dwordx4 v11, s[28:31], s56 offen offset:3072 lds
    s_add_u32 s56, s56, 524288
    s_cmp_ge_u32 s56, s58
    s_cselect_b32 s56, s57, s56
    ds_read_b64_tr_b16 v[80:81], v21 offset:64
    ds_read_b64_tr_b16 v[82:83], v21 offset:832
    s_waitcnt lgkmcnt(8)
    v_mfma_f32_16x16x32_bf16 v[76:79], v[88:91], v[188:191], v[76:79]
    v_mfma_f32_16x16x32_bf16 v[52:55], v[88:91], v[184:187], v[52:55]
    ds_read_b64_tr_b16 v[84:85], v20 offset:128
    ds_read_b64_tr_b16 v[86:87], v20 offset:896
    s_waitcnt vmcnt(12)
    s_waitcnt lgkmcnt(8)
    v_mfma_f32_16x16x32_bf16 v[68:71], v[92:95], v[196:199], v[68:71]
    v_mfma_f32_16x16x32_bf16 v[44:47], v[92:95], v[192:195], v[44:47]
    s_add_u32 m0, s5, 49152
    s_nop 0
    buffer_load_dwordx4 v8, s[28:31], s56 offen offset:0 lds
    ds_read_b64_tr_b16 v[88:89], v21 offset:128
    ds_read_b64_tr_b16 v[90:91], v21 offset:896
    s_waitcnt lgkmcnt(8)
    v_mfma_f32_16x16x32_bf16 v[72:75], v[96:99], v[196:199], v[72:75]
    v_mfma_f32_16x16x32_bf16 v[48:51], v[96:99], v[192:195], v[48:51]
    ds_read_b64_tr_b16 v[92:93], v21 offset:6208
    ds_read_b64_tr_b16 v[94:95], v21 offset:6976
    s_waitcnt lgkmcnt(8)
    v_mfma_f32_16x16x32_bf16 v[76:79], v[100:103], v[196:199], v[76:79]
    v_mfma_f32_16x16x32_bf16 v[52:55], v[100:103], v[192:195], v[52:55]
    buffer_load_dwordx4 v9, s[28:31], s56 offen offset:1024 lds
    ds_read_b64_tr_b16 v[96:97], v20 offset:6272
    ds_read_b64_tr_b16 v[98:99], v20 offset:7040
    s_waitcnt vmcnt(12)
    s_waitcnt lgkmcnt(8)
    v_mfma_f32_16x16x32_bf16 v[68:71], v[80:83], v[204:207], v[68:71]
    v_mfma_f32_16x16x32_bf16 v[44:47], v[80:83], v[200:203], v[44:47]
    ds_read_b64_tr_b16 v[100:101], v21 offset:6272
    ds_read_b64_tr_b16 v[102:103], v21 offset:7040
    s_waitcnt lgkmcnt(8)
    v_mfma_f32_16x16x32_bf16 v[72:75], v[84:87], v[204:207], v[72:75]
    v_mfma_f32_16x16x32_bf16 v[48:51], v[84:87], v[200:203], v[48:51]
    buffer_load_dwordx4 v10, s[28:31], s56 offen offset:2048 lds
    ds_read_b64_tr_b16 v[80:81], v21 offset:24640
    ds_read_b64_tr_b16 v[82:83], v21 offset:25408
    s_waitcnt lgkmcnt(8)
    v_mfma_f32_16x16x32_bf16 v[76:79], v[88:91], v[204:207], v[76:79]
    v_mfma_f32_16x16x32_bf16 v[52:55], v[88:91], v[200:203], v[52:55]
    ds_read_b64_tr_b16 v[84:85], v20 offset:24704
    ds_read_b64_tr_b16 v[86:87], v20 offset:25472
    s_waitcnt vmcnt(11)
    s_waitcnt lgkmcnt(8)
    v_mfma_f32_16x16x32_bf16 v[68:71], v[92:95], v[212:215], v[68:71]
    v_mfma_f32_16x16x32_bf16 v[44:47], v[92:95], v[208:211], v[44:47]
    buffer_load_dwordx4 v11, s[28:31], s56 offen offset:3072 lds
    s_add_u32 s56, s56, 524288
    s_cmp_ge_u32 s56, s58
    s_cselect_b32 s56, s57, s56
    ds_read_b64_tr_b16 v[88:89], v21 offset:24704
    ds_read_b64_tr_b16 v[90:91], v21 offset:25472
    s_waitcnt lgkmcnt(8)
    v_mfma_f32_16x16x32_bf16 v[72:75], v[96:99], v[212:215], v[72:75]
    v_mfma_f32_16x16x32_bf16 v[48:51], v[96:99], v[208:211], v[48:51]
    ds_read_b64_tr_b16 v[92:93], v21 offset:30784
    ds_read_b64_tr_b16 v[94:95], v21 offset:31552
    s_waitcnt lgkmcnt(8)
    v_mfma_f32_16x16x32_bf16 v[76:79], v[100:103], v[212:215], v[76:79]
    v_mfma_f32_16x16x32_bf16 v[52:55], v[100:103], v[208:211], v[52:55]
    ds_read_b64_tr_b16 v[96:97], v20 offset:30848
    ds_read_b64_tr_b16 v[98:99], v20 offset:31616
    s_waitcnt vmcnt(10)
    s_waitcnt lgkmcnt(8)
    v_mfma_f32_16x16x32_bf16 v[68:71], v[80:83], v[220:223], v[68:71]
    v_mfma_f32_16x16x32_bf16 v[44:47], v[80:83], v[216:219], v[44:47]
    ds_read_b64_tr_b16 v[100:101], v21 offset:30848
    ds_read_b64_tr_b16 v[102:103], v21 offset:31616
    s_waitcnt lgkmcnt(8)
    v_mfma_f32_16x16x32_bf16 v[72:75], v[84:87], v[220:223], v[72:75]
    v_mfma_f32_16x16x32_bf16 v[48:51], v[84:87], v[216:219], v[48:51]
    s_waitcnt lgkmcnt(6)
    v_mfma_f32_16x16x32_bf16 v[76:79], v[88:91], v[220:223], v[76:79]
    v_mfma_f32_16x16x32_bf16 v[52:55], v[88:91], v[216:219], v[52:55]
    s_waitcnt vmcnt(8)
    s_waitcnt lgkmcnt(4)
    v_mfma_f32_16x16x32_bf16 v[68:71], v[92:95], v[228:231], v[68:71]
    v_mfma_f32_16x16x32_bf16 v[44:47], v[92:95], v[224:227], v[44:47]
    s_waitcnt lgkmcnt(2)
    v_mfma_f32_16x16x32_bf16 v[72:75], v[96:99], v[228:231], v[72:75]
    v_mfma_f32_16x16x32_bf16 v[48:51], v[96:99], v[224:227], v[48:51]
    s_waitcnt lgkmcnt(0)
    v_mfma_f32_16x16x32_bf16 v[76:79], v[100:103], v[228:231], v[76:79]
    v_mfma_f32_16x16x32_bf16 v[52:55], v[100:103], v[224:227], v[52:55]
    v_mfma_f32_16x16x32_bf16 v[56:59], a[48:51], v[124:127], v[56:59]
    v_mfma_f32_16x16x32_bf16 v[32:35], a[48:51], v[120:123], v[32:35]
    v_mfma_f32_16x16x32_bf16 v[60:63], a[52:55], v[124:127], v[60:63]
    v_mfma_f32_16x16x32_bf16 v[36:39], a[52:55], v[120:123], v[36:39]
    ds_write_b128 v253, v[68:71] offset:3072
    v_mfma_f32_16x16x32_bf16 v[64:67], a[56:59], v[124:127], v[64:67]
    v_mfma_f32_16x16x32_bf16 v[40:43], a[56:59], v[120:123], v[40:43]
    ds_write_b128 v253, v[72:75] offset:4096
    v_mfma_f32_16x16x32_bf16 v[56:59], a[72:75], v[132:135], v[56:59]
    v_mfma_f32_16x16x32_bf16 v[32:35], a[72:75], v[128:131], v[32:35]
    ds_write_b128 v253, v[76:79] offset:5120
    v_mfma_f32_16x16x32_bf16 v[60:63], a[76:79], v[132:135], v[60:63]
    v_mfma_f32_16x16x32_bf16 v[36:39], a[76:79], v[128:131], v[36:39]
    s_waitcnt lgkmcnt(0)
    s_barrier
    ds_read_b128 v[68:71], v254 offset:3072
    ds_read_b128 v[72:75], v254 offset:4096
    ds_read_b128 v[76:79], v254 offset:5120
    s_and_b32 s92, s97, 0xff
    v_mov_b32 v250, 0xffffff00
    v_mfma_f32_16x16x32_bf16 v[64:67], a[80:83], v[132:135], v[64:67]
    v_mfma_f32_16x16x32_bf16 v[40:43], a[80:83], v[128:131], v[40:43]
    v_mfma_f32_16x16x32_bf16 v[56:59], a[96:99], v[140:143], v[56:59]
    v_mfma_f32_16x16x32_bf16 v[32:35], a[96:99], v[136:139], v[32:35]
    v_mfma_f32_16x16x32_bf16 v[60:63], a[100:103], v[140:143], v[60:63]
    v_mfma_f32_16x16x32_bf16 v[36:39], a[100:103], v[136:139], v[36:39]
    s_waitcnt lgkmcnt(0)
    v_pk_add_f32 v[68:69], v[44:45], v[68:69]
    v_pk_add_f32 v[70:71], v[46:47], v[70:71]
    v_pk_add_f32 v[72:73], v[48:49], v[72:73]
    v_pk_add_f32 v[74:75], v[50:51], v[74:75]
    v_pk_add_f32 v[76:77], v[52:53], v[76:77]
    v_pk_add_f32 v[78:79], v[54:55], v[78:79]
    v_mfma_f32_16x16x32_bf16 v[64:67], a[104:107], v[140:143], v[64:67]
    v_mfma_f32_16x16x32_bf16 v[40:43], a[104:107], v[136:139], v[40:43]
    v_and_or_b32 v68, v68, v250, s92
    v_and_or_b32 v69, v69, v250, s92
    v_and_or_b32 v70, v70, v250, s92
    v_and_or_b32 v71, v71, v250, s92
    buffer_store_dwordx4 v[68:71], v7, s[8:11], s6 offen offset:0 sc1
    v_mfma_f32_16x16x32_bf16 v[56:59], a[120:123], v[148:151], v[56:59]
    v_mfma_f32_16x16x32_bf16 v[32:35], a[120:123], v[144:147], v[32:35]
    v_and_or_b32 v72, v72, v250, s92
    v_and_or_b32 v73, v73, v250, s92
    v_and_or_b32 v74, v74, v250, s92
    v_and_or_b32 v75, v75, v250, s92
    buffer_store_dwordx4 v[72:75], v7, s[8:11], s6 offen offset:1024 sc1
    v_mfma_f32_16x16x32_bf16 v[60:63], a[124:127], v[148:151], v[60:63]
    v_mfma_f32_16x16x32_bf16 v[36:39], a[124:127], v[144:147], v[36:39]
    v_and_or_b32 v76, v76, v250, s92
    v_and_or_b32 v77, v77, v250, s92
    v_and_or_b32 v78, v78, v250, s92
    v_and_or_b32 v79, v79, v250, s92
    buffer_store_dwordx4 v[76:79], v7, s[8:11], s6 offen offset:2048 sc1
    v_mfma_f32_16x16x32_bf16 v[64:67], a[128:131], v[148:151], v[64:67]
    v_mfma_f32_16x16x32_bf16 v[40:43], a[128:131], v[144:147], v[40:43]
    v_mfma_f32_16x16x32_bf16 v[56:59], a[144:147], v[156:159], v[56:59]
    s_mov_b32 s4, 32768
    v_mul_u32_u24 v29, 64, v0
    v_mfma_f32_16x16x32_bf16 v[32:35], a[144:147], v[152:155], v[32:35]
    v_mfma_f32_16x16x32_bf16 v[60:63], a[148:151], v[156:159], v[60:63]
    v_mfma_f32_16x16x32_bf16 v[36:39], a[148:151], v[152:155], v[36:39]
    ds_read_b64_tr_b16 v[80:81], v24 offset:24576
    ds_read_b64_tr_b16 v[82:83], v24 offset:25344
    v_mfma_f32_16x16x32_bf16 v[64:67], a[152:155], v[156:159], v[64:67]
    buffer_load_dword v28, v29, s[44:47], s4 offen sc1
    v_mfma_f32_16x16x32_bf16 v[40:43], a[152:155], v[152:155], v[40:43]
    ds_read_b64_tr_b16 v[84:85], v25 offset:24576
    ds_read_b64_tr_b16 v[86:87], v25 offset:25344
    v_mfma_f32_16x16x32_bf16 v[56:59], a[168:171], v[164:167], v[56:59]
    v_mfma_f32_16x16x32_bf16 v[32:35], a[168:171], v[160:163], v[32:35]
    ds_read_b64_tr_b16 v[88:89], v24 offset:24640
    ds_read_b64_tr_b16 v[90:91], v24 offset:25408
    v_mfma_f32_16x16x32_bf16 v[60:63], a[172:175], v[164:167], v[60:63]
    s_add_u32 m0, s5, 65536
    s_nop 0
    buffer_load_dwordx4 v8, s[28:31], s56 offen offset:0 lds
    v_mfma_f32_16x16x32_bf16 v[36:39], a[172:175], v[160:163], v[36:39]
    ds_read_b64_tr_b16 v[92:93], v24 offset:30720
    ds_read_b64_tr_b16 v[94:95], v24 offset:31488
    v_mfma_f32_16x16x32_bf16 v[64:67], a[176:179], v[164:167], v[64:67]
    v_mfma_f32_16x16x32_bf16 v[40:43], a[176:179], v[160:163], v[40:43]
    ds_read_b64_tr_b16 v[96:97], v25 offset:30720
    ds_read_b64_tr_b16 v[98:99], v25 offset:31488
    v_mfma_f32_16x16x32_bf16 v[56:59], a[192:195], v[172:175], v[56:59]
    buffer_load_dwordx4 v9, s[28:31], s56 offen offset:1024 lds
    v_mfma_f32_16x16x32_bf16 v[32:35], a[192:195], v[168:171], v[32:35]
    v_mfma_f32_16x16x32_bf16 v[60:63], a[196:199], v[172:175], v[60:63]
    v_mfma_f32_16x16x32_bf16 v[36:39], a[196:199], v[168:171], v[36:39]
    v_mfma_f32_16x16x32_bf16 v[64:67], a[200:203], v[172:175], v[64:67]
    buffer_load_dwordx4 v10, s[28:31], s56 offen offset:2048 lds
    v_mfma_f32_16x16x32_bf16 v[40:43], a[200:203], v[168:171], v[40:43]
    v_mfma_f32_16x16x32_bf16 v[56:59], a[216:219], v[180:183], v[56:59]
    v_mfma_f32_16x16x32_bf16 v[32:35], a[216:219], v[176:179], v[32:35]
    v_mfma_f32_16x16x32_bf16 v[60:63], a[220:223], v[180:183], v[60:63]
    buffer_load_dwordx4 v11, s[28:31], s56 offen offset:3072 lds
    s_add_u32 s56, s56, 524288
    s_cmp_ge_u32 s56, s58
    s_cselect_b32 s56, s57, s56
    v_mfma_f32_16x16x32_bf16 v[36:39], a[220:223], v[176:179], v[36:39]
    v_mfma_f32_16x16x32_bf16 v[64:67], a[224:227], v[180:183], v[64:67]
    v_mfma_f32_16x16x32_bf16 v[40:43], a[224:227], v[176:179], v[40:43]
    s_waitcnt lgkmcnt(8)
    v_mfma_f32_16x16x32_bf16 v[56:59], v[80:83], v[188:191], v[56:59]
    s_add_u32 m0, s5, 81920
    s_nop 0
    buffer_load_dwordx4 v8, s[28:31], s56 offen offset:0 lds
    v_mfma_f32_16x16x32_bf16 v[32:35], v[80:83], v[184:187], v[32:35]
    ds_read_b64_tr_b16 v[100:101], v24 offset:30784
    ds_read_b64_tr_b16 v[102:103], v24 offset:31552
    s_waitcnt lgkmcnt(8)
    v_mfma_f32_16x16x32_bf16 v[60:63], v[84:87], v[188:191], v[60:63]
    v_mfma_f32_16x16x32_bf16 v[36:39], v[84:87], v[184:187], v[36:39]
    ds_read_b64_tr_b16 v[80:81], v20 offset:0
    ds_read_b64_tr_b16 v[82:83], v20 offset:768
    s_waitcnt lgkmcnt(8)
    v_mfma_f32_16x16x32_bf16 v[64:67], v[88:91], v[188:191], v[64:67]
    buffer_load_dwordx4 v9, s[28:31], s56 offen offset:1024 lds
    v_mfma_f32_16x16x32_bf16 v[40:43], v[88:91], v[184:187], v[40:43]
    ds_read_b64_tr_b16 v[84:85], v21 offset:0
    ds_read_b64_tr_b16 v[86:87], v21 offset:768
    s_waitcnt lgkmcnt(8)
    v_mfma_f32_16x16x32_bf16 v[56:59], v[92:95], v[196:199], v[56:59]
    v_mfma_f32_16x16x32_bf16 v[32:35], v[92:95], v[192:195], v[32:35]
    ds_read_b64_tr_b16 v[88:89], v20 offset:64
    ds_read_b64_tr_b16 v[90:91], v20 offset:832
    s_waitcnt lgkmcnt(8)
    v_mfma_f32_16x16x32_bf16 v[60:63], v[96:99], v[196:199], v[60:63]
    buffer_load_dwordx4 v10, s[28:31], s56 offen offset:2048 lds
    v_mfma_f32_16x16x32_bf16 v[36:39], v[96:99], v[192:195], v[36:39]
    ds_read_b64_tr_b16 v[92:93], v20 offset:6144
    ds_read_b64_tr_b16 v[94:95], v20 offset:6912
    s_waitcnt lgkmcnt(8)
    v_mfma_f32_16x16x32_bf16 v[64:67], v[100:103], v[196:199], v[64:67]
    v_mfma_f32_16x16x32_bf16 v[40:43], v[100:103], v[192:195], v[40:43]
    ds_read_b64_tr_b16 v[96:97], v21 offset:6144
    ds_read_b64_tr_b16 v[98:99], v21 offset:6912
    s_waitcnt lgkmcnt(8)
    v_mfma_f32_16x16x32_bf16 v[56:59], v[80:83], v[204:207], v[56:59]
    buffer_load_dwordx4 v11, s[28:31], s56 offen offset:3072 lds
    s_add_u32 s56, s56, 524288
    s_cmp_ge_u32 s56, s58
    s_cselect_b32 s56, s57, s56
    v_mfma_f32_16x16x32_bf16 v[32:35], v[80:83], v[200:203], v[32:35]
    ds_read_b64_tr_b16 v[100:101], v20 offset:6208
    ds_read_b64_tr_b16 v[102:103], v20 offset:6976
    s_waitcnt lgkmcnt(8)
    v_mfma_f32_16x16x32_bf16 v[60:63], v[84:87], v[204:207], v[60:63]
    v_mfma_f32_16x16x32_bf16 v[36:39], v[84:87], v[200:203], v[36:39]
    ds_read_b64_tr_b16 v[80:81], v20 offset:24576
    ds_read_b64_tr_b16 v[82:83], v20 offset:25344
    s_waitcnt lgkmcnt(8)
    v_mfma_f32_16x16x32_bf16 v[64:67], v[88:91], v[204:207], v[64:67]
    v_mfma_f32_16x16x32_bf16 v[40:43], v[88:91], v[200:203], v[40:43]
    ds_read_b64_tr_b16 v[84:85], v21 offset:24576
    ds_read_b64_tr_b16 v[86:87], v21 offset:25344
    s_waitcnt lgkmcnt(8)
    v_mfma_f32_16x16x32_bf16 v[56:59], v[92:95], v[212:215], v[56:59]
    v_mfma_f32_16x16x32_bf16 v[32:35], v[92:95], v[208:211], v[32:35]
    ds_read_b64_tr_b16 v[88:89], v20 offset:24640
    ds_read_b64_tr_b16 v[90:91], v20 offset:25408
    s_waitcnt lgkmcnt(8)
    v_mfma_f32_16x16x32_bf16 v[60:63], v[96:99], v[212:215], v[60:63]
    v_mfma_f32_16x16x32_bf16 v[36:39], v[96:99], v[208:211], v[36:39]
    ds_read_b64_tr_b16 v[92:93], v20 offset:30720
    ds_read_b64_tr_b16 v[94:95], v20 offset:31488
    s_waitcnt lgkmcnt(8)
    v_mfma_f32_16x16x32_bf16 v[64:67], v[100:103], v[212:215], v[64:67]
    v_mfma_f32_16x16x32_bf16 v[40:43], v[100:103], v[208:211], v[40:43]
    ds_read_b64_tr_b16 v[96:97], v21 offset:30720
    ds_read_b64_tr_b16 v[98:99], v21 offset:31488
    s_waitcnt lgkmcnt(8)
    v_mfma_f32_16x16x32_bf16 v[56:59], v[80:83], v[220:223], v[56:59]
    v_mfma_f32_16x16x32_bf16 v[32:35], v[80:83], v[216:219], v[32:35]
    ds_read_b64_tr_b16 v[100:101], v20 offset:30784
    ds_read_b64_tr_b16 v[102:103], v20 offset:31552
    s_waitcnt lgkmcnt(8)
    v_mfma_f32_16x16x32_bf16 v[60:63], v[84:87], v[220:223], v[60:63]
    v_mfma_f32_16x16x32_bf16 v[36:39], v[84:87], v[216:219], v[36:39]
    s_waitcnt lgkmcnt(6)
    v_mfma_f32_16x16x32_bf16 v[64:67], v[88:91], v[220:223], v[64:67]
    v_mfma_f32_16x16x32_bf16 v[40:43], v[88:91], v[216:219], v[40:43]
    s_waitcnt lgkmcnt(4)
    v_mfma_f32_16x16x32_bf16 v[56:59], v[92:95], v[228:231], v[56:59]
    v_mfma_f32_16x16x32_bf16 v[32:35], v[92:95], v[224:227], v[32:35]
    s_waitcnt lgkmcnt(2)
    v_mfma_f32_16x16x32_bf16 v[60:63], v[96:99], v[228:231], v[60:63]
    v_mfma_f32_16x16x32_bf16 v[36:39], v[96:99], v[224:227], v[36:39]
    s_waitcnt lgkmcnt(0)
    v_mfma_f32_16x16x32_bf16 v[64:67], v[100:103], v[228:231], v[64:67]
    v_mfma_f32_16x16x32_bf16 v[40:43], v[100:103], v[224:227], v[40:43]
    s_nop 1
    v_lshlrev_b32 v68, 16, v244
    v_and_b32 v69, 0xffff0000, v244
    v_lshlrev_b32 v70, 16, v245
    v_and_b32 v71, 0xffff0000, v245
    v_lshlrev_b32 v72, 16, v246
    v_and_b32 v73, 0xffff0000, v246
    ds_write_b128 v253, v[56:59] offset:0
    ds_write_b128 v253, v[60:63] offset:1024
    ds_write_b128 v253, v[64:67] offset:2048
    v_lshlrev_b32 v74, 16, v247
    v_and_b32 v75, 0xffff0000, v247
    v_lshlrev_b32 v76, 16, v248
    v_and_b32 v77, 0xffff0000, v248
    v_lshlrev_b32 v78, 16, v249
    v_and_b32 v79, 0xffff0000, v249
    v_mov_b32 v104, 0xbdd2d3e8
    v_mov_b32 v106, 0xc0135761
    v_mov_b32 v108, 1.0
    v_pk_add_f32 v[32:33], v[32:33], v[68:69]
    v_pk_add_f32 v[34:35], v[34:35], v[70:71]
    v_pk_add_f32 v[36:37], v[36:37], v[72:73]
    v_pk_add_f32 v[38:39], v[38:39], v[74:75]
    v_pk_add_f32 v[40:41], v[40:41], v[76:77]
    v_pk_add_f32 v[42:43], v[42:43], v[78:79]
    s_waitcnt vmcnt(9)
    buffer_load_dwordx4 v[44:47], v7, s[8:11], s7 offen offset:0 sc1
    buffer_load_dwordx4 v[48:51], v7, s[8:11], s7 offen offset:1024 sc1
    buffer_load_dwordx4 v[52:55], v7, s[8:11], s7 offen offset:2048 sc1
    v_and_b32 v31, 15, v1
    v_lshlrev_b32 v31, 1, v31
    s_lshl_b32 s65, s63, 7
    buffer_load_ushort v20, v31, s[52:55], s65 offen offset:0
    buffer_load_ushort v21, v31, s[52:55], s65 offen offset:32
    buffer_load_ushort v22, v31, s[52:55], s65 offen offset:64
    buffer_load_ushort v23, v31, s[52:55], s65 offen offset:96
    s_waitcnt vmcnt(15)
    v_cmp_ne_u32 vcc, s97, v28
    s_cbranch_vccnz L_fretry1
L_fok1:
    s_waitcnt vmcnt(11)
    s_waitcnt vmcnt(7)
    s_waitcnt lgkmcnt(0)
    s_barrier
    s_add_u32 m0, s5, 0
    s_nop 0
    buffer_load_dwordx4 v8, s[28:31], s56 offen offset:0 lds
    buffer_load_dwordx4 v9, s[28:31], s56 offen offset:1024 lds
    buffer_load_dwordx4 v10, s[28:31], s56 offen offset:2048 lds
    buffer_load_dwordx4 v11, s[28:31], s56 offen offset:3072 lds
    s_add_u32 s56, s56, 524288
    s_cmp_ge_u32 s56, s58
    s_cselect_b32 s56, s57, s56
    s_add_u32 m0, s5, 16384
    s_nop 0
    buffer_load_dwordx4 v8, s[28:31], s56 offen offset:0 lds
    buffer_load_dwordx4 v9, s[28:31], s56 offen offset:1024 lds
    buffer_load_dwordx4 v10, s[28:31], s56 offen offset:2048 lds
    buffer_load_dwordx4 v11, s[28:31], s56 offen offset:3072 lds
    s_add_u32 s56, s56, 524288
    s_cmp_ge_u32 s56, s58
    s_cselect_b32 s56, s57, s56
    ds_read_b128 v[56:59], v254 offset:0
    ds_read_b128 v[60:63], v254 offset:1024
    ds_read_b128 v[64:67], v254 offset:2048
    s_waitcnt lgkmcnt(0)
    v_pk_add_f32 v[32:33], v[32:33], v[56:57]
    v_pk_add_f32 v[34:35], v[34:35], v[58:59]
    v_pk_add_f32 v[36:37], v[36:37], v[60:61]
    v_pk_add_f32 v[38:39], v[38:39], v[62:63]
    v_pk_add_f32 v[40:41], v[40:41], v[64:65]
    v_pk_add_f32 v[42:43], v[42:43], v[66:67]
    ds_read_b64_tr_b16 a[0:1], v240 offset:16384
    ds_read_b64_tr_b16 a[2:3], v240 offset:16896
    ds_read_b64_tr_b16 a[4:5], v241 offset:16384
    ds_read_b64_tr_b16 a[6:7], v241 offset:16896
    ds_read_b64_tr_b16 a[8:9], v242 offset:16384
    ds_read_b64_tr_b16 a[10:11], v242 offset:16896
    ds_read_b64_tr_b16 a[12:13], v243 offset:16384
    ds_read_b64_tr_b16 a[14:15], v243 offset:16896
    ds_read_b64_tr_b16 a[16:17], v240 offset:20480
    ds_read_b64_tr_b16 a[18:19], v240 offset:20992
    ds_read_b64_tr_b16 a[20:21], v241 offset:20480
    ds_read_b64_tr_b16 a[22:23], v241 offset:20992
    ds_read_b64_tr_b16 a[24:25], v242 offset:20480
    ds_read_b64_tr_b16 a[26:27], v242 offset:20992
    ds_read_b64_tr_b16 a[28:29], v243 offset:20480
    ds_read_b64_tr_b16 a[30:31], v243 offset:20992
    ds_read_b64_tr_b16 a[32:33], v232 offset:49152
    ds_read_b64_tr_b16 a[34:35], v232 offset:49664
    ds_read_b64_tr_b16 a[36:37], v233 offset:49152
    ds_read_b64_tr_b16 a[38:39], v233 offset:49664
    ds_read_b64_tr_b16 a[40:41], v234 offset:49152
    ds_read_b64_tr_b16 a[42:43], v234 offset:49664
    ds_read_b64_tr_b16 a[44:45], v235 offset:49152
    ds_read_b64_tr_b16 a[46:47], v235 offset:49664
    ds_read_b64_tr_b16 a[48:49], v232 offset:53248
    ds_read_b64_tr_b16 a[50:51], v232 offset:53760
    ds_read_b64_tr_b16 a[52:53], v233 offset:53248
    ds_read_b64_tr_b16 a[54:55], v233 offset:53760
    ds_read_b64_tr_b16 a[56:57], v234 offset:53248
    ds_read_b64_tr_b16 a[58:59], v234 offset:53760
    ds_read_b64_tr_b16 a[60:61], v235 offset:53248
    ds_read_b64_tr_b16 a[62:63], v235 offset:53760
    ds_read_b64_tr_b16 a[64:65], v236 offset:0
    ds_read_b64_tr_b16 a[66:67], v236 offset:512
    ds_read_b64_tr_b16 a[68:69], v237 offset:0
    ds_read_b64_tr_b16 a[70:71], v237 offset:512
    ds_read_b64_tr_b16 a[72:73], v238 offset:0
    ds_read_b64_tr_b16 a[74:75], v238 offset:512
    ds_read_b64_tr_b16 a[76:77], v239 offset:0
    ds_read_b64_tr_b16 a[78:79], v239 offset:512
    ds_read_b64_tr_b16 a[80:81], v236 offset:4096
    ds_read_b64_tr_b16 a[82:83], v236 offset:4608
    ds_read_b64_tr_b16 a[84:85], v237 offset:4096
    ds_read_b64_tr_b16 a[86:87], v237 offset:4608
    ds_read_b64_tr_b16 a[88:89], v238 offset:4096
    ds_read_b64_tr_b16 a[90:91], v238 offset:4608
    ds_read_b64_tr_b16 a[92:93], v239 offset:4096
    ds_read_b64_tr_b16 a[94:95], v239 offset:4608
    s_mov_b32 s75, 20000
    s_waitcnt vmcnt(12)
L_pxchk:
    v_xor_b32 v30, s92, v44
    v_xor_b32 v31, s92, v45
    v_bitop3_b32 v30, v46, s92, v30 bitop3:0xbe
    v_bitop3_b32 v31, v47, s92, v31 bitop3:0xbe
    v_bitop3_b32 v30, v48, s92, v30 bitop3:0xbe
    v_bitop3_b32 v31, v49, s92, v31 bitop3:0xbe
    v_bitop3_b32 v30, v50, s92, v30 bitop3:0xbe
    v_bitop3_b32 v31, v51, s92, v31 bitop3:0xbe
    v_bitop3_b32 v30, v52, s92, v30 bitop3:0xbe
    v_bitop3_b32 v31, v53, s92, v31 bitop3:0xbe
    v_bitop3_b32 v30, v54, s92, v30 bitop3:0xbe
    v_bitop3_b32 v31, v55, s92, v31 bitop3:0xbe
    v_or_b32 v30, v30, v31
    v_and_b32 v30, 0xff, v30
    v_cmp_ne_u32 vcc, 0, v30
    s_cbranch_vccnz L_pxretry
L_pxok:
    v_pk_add_f32 v[32:33], v[32:33], v[44:45]
    s_add_u32 m0, s5, 32768
    s_nop 0
    buffer_load_dwordx4 v8, s[28:31], s56 offen offset:0 lds
    v_pk_add_f32 v[34:35], v[34:35], v[46:47]
    v_pk_add_f32 v[36:37], v[36:37], v[48:49]
    v_pk_add_f32 v[38:39], v[38:39], v[50:51]
    v_pk_add_f32 v[40:41], v[40:41], v[52:53]
    v_pk_add_f32 v[42:43], v[42:43], v[54:55]
    v_pk_mul_f32 v[56:57], v[32:33], v[32:33]
    v_pk_mul_f32 v[58:59], v[34:35], v[34:35]
    v_pk_mul_f32 v[60:61], v[36:37], v[36:37]
    v_pk_mul_f32 v[62:63], v[38:39], v[38:39]
    v_pk_mul_f32 v[64:65], v[40:41], v[40:41]
    v_pk_mul_f32 v[66:67], v[42:43], v[42:43]
    v_pk_fma_f32 v[56:57], v[56:57], v[104:105], v[106:107] op_sel_hi:[1,0,0]
    v_pk_fma_f32 v[58:59], v[58:59], v[104:105], v[106:107] op_sel_hi:[1,0,0]
    v_pk_fma_f32 v[60:61], v[60:61], v[104:105], v[106:107] op_sel_hi:[1,0,0]
    v_pk_fma_f32 v[62:63], v[62:63], v[104:105], v[106:107] op_sel_hi:[1,0,0]
    v_pk_fma_f32 v[64:65], v[64:65], v[104:105], v[106:107] op_sel_hi:[1,0,0]
    buffer_load_dwordx4 v9, s[28:31], s56 offen offset:1024 lds
    v_pk_fma_f32 v[66:67], v[66:67], v[104:105], v[106:107] op_sel_hi:[1,0,0]
    v_pk_mul_f32 v[56:57], v[56:57], v[32:33]
    v_pk_mul_f32 v[58:59], v[58:59], v[34:35]
    v_pk_mul_f32 v[60:61], v[60:61], v[36:37]
    v_pk_mul_f32 v[62:63], v[62:63], v[38:39]
    v_pk_mul_f32 v[64:65], v[64:65], v[40:41]
    v_pk_mul_f32 v[66:67], v[66:67], v[42:43]
    v_exp_f32 v56, v56
    v_exp_f32 v57, v57
    v_exp_f32 v58, v58
    v_exp_f32 v59, v59
    v_exp_f32 v60, v60
    buffer_load_dwordx4 v10, s[28:31], s56 offen offset:2048 lds
    v_exp_f32 v61, v61
    v_exp_f32 v62, v62
    v_exp_f32 v63, v63
    v_exp_f32 v64, v64
    v_exp_f32 v65, v65
    v_exp_f32 v66, v66
    v_exp_f32 v67, v67
    v_pk_add_f32 v[56:57], v[56:57], v[108:109] op_sel_hi:[1,0]
    v_pk_add_f32 v[58:59], v[58:59], v[108:109] op_sel_hi:[1,0]
    buffer_load_dwordx4 v11, s[28:31], s56 offen offset:3072 lds
    s_add_u32 s56, s56, 524288
    s_cmp_ge_u32 s56, s58
    s_cselect_b32 s56, s57, s56
    v_pk_add_f32 v[60:61], v[60:61], v[108:109] op_sel_hi:[1,0]
    v_pk_add_f32 v[62:63], v[62:63], v[108:109] op_sel_hi:[1,0]
    v_pk_add_f32 v[64:65], v[64:65], v[108:109] op_sel_hi:[1,0]
    v_pk_add_f32 v[66:67], v[66:67], v[108:109] op_sel_hi:[1,0]
    v_rcp_f32 v56, v56
    v_rcp_f32 v57, v57
    v_rcp_f32 v58, v58
    v_rcp_f32 v59, v59
    v_rcp_f32 v60, v60
    v_rcp_f32 v61, v61
    s_add_u32 m0, s5, 131072
    s_nop 0
    buffer_load_dwordx4 v8, s[28:31], s56 offen offset:0 lds
    v_rcp_f32 v62, v62
    v_rcp_f32 v63, v63
    v_rcp_f32 v64, v64
    v_rcp_f32 v65, v65
    v_rcp_f32 v66, v66
    v_rcp_f32 v67, v67
    v_pk_mul_f32 v[32:33], v[32:33], v[56:57]
    v_pk_mul_f32 v[34:35], v[34:35], v[58:59]
    v_pk_mul_f32 v[36:37], v[36:37], v[60:61]
    v_pk_mul_f32 v[38:39], v[38:39], v[62:63]
    buffer_load_dwordx4 v9, s[28:31], s56 offen offset:1024 lds
    v_pk_mul_f32 v[40:41], v[40:41], v[64:65]
    v_pk_mul_f32 v[42:43], v[42:43], v[66:67]
    v_cvt_pk_bf16_f32 v72, v32, v33
    v_cvt_pk_bf16_f32 v73, v34, v35
    v_cvt_pk_bf16_f32 v74, v36, v37
    v_cvt_pk_bf16_f32 v75, v38, v39
    v_cvt_pk_bf16_f32 v76, v40, v41
    v_cvt_pk_bf16_f32 v77, v42, v43
    v_min_u32 v72, -2, v72
    v_min_u32 v73, -2, v73
    v_min_u32 v74, -2, v74
    v_min_u32 v75, -2, v75
    v_min_u32 v76, -2, v76
    v_min_u32 v77, -2, v77
    v_mov_b32 v78, v76
    v_mov_b32 v79, v77
    s_nop 0
    v_permlane16_swap_b32 v72, v74
    v_permlane16_swap_b32 v73, v75
    v_permlane16_swap_b32 v76, v78
    v_permlane16_swap_b32 v77, v79
    buffer_store_dwordx4 v[72:75], v26, s[36:39], s100 offen sc1
    buffer_store_dwordx4 v[76:79], v27, s[36:39], s100 offen sc1
    s_waitcnt vmcnt(16)
    v_lshlrev_b32 v32, 16, v20
    v_mov_b32 v33, v32
    v_mov_b32 v34, v32
    v_mov_b32 v35, v32
    v_lshlrev_b32 v36, 16, v21
    v_mov_b32 v37, v36
    v_mov_b32 v38, v36
    v_mov_b32 v39, v36
    v_lshlrev_b32 v40, 16, v22
    v_mov_b32 v41, v40
    v_mov_b32 v42, v40
    v_mov_b32 v43, v40
    v_lshlrev_b32 v44, 16, v23
    v_mov_b32 v45, v44
    v_mov_b32 v46, v44
    v_mov_b32 v47, v44
    v_mov_b64 v[48:49], 0
    v_mov_b64 v[50:51], 0
    v_mov_b64 v[52:53], 0
    v_mov_b64 v[54:55], 0
    v_mov_b64 v[56:57], 0
    v_mov_b64 v[58:59], 0
    v_mov_b64 v[60:61], 0
    v_mov_b64 v[62:63], 0
    buffer_load_dwordx4 v10, s[28:31], s56 offen offset:2048 lds
    buffer_load_dwordx4 v11, s[28:31], s56 offen offset:3072 lds
    s_add_u32 s56, s56, 524288
    s_cmp_ge_u32 s56, s58
    s_cselect_b32 s56, s57, s56
    ds_read_b64_tr_b16 a[96:97], v236 offset:16384
    ds_read_b64_tr_b16 a[98:99], v236 offset:16896
    ds_read_b64_tr_b16 a[100:101], v237 offset:16384
    ds_read_b64_tr_b16 a[102:103], v237 offset:16896
    ds_read_b64_tr_b16 a[104:105], v238 offset:16384
    ds_read_b64_tr_b16 a[106:107], v238 offset:16896
    ds_read_b64_tr_b16 a[108:109], v239 offset:16384
    ds_read_b64_tr_b16 a[110:111], v239 offset:16896
    ds_read_b64_tr_b16 a[112:113], v236 offset:20480
    ds_read_b64_tr_b16 a[114:115], v236 offset:20992
    ds_read_b64_tr_b16 a[116:117], v237 offset:20480
    ds_read_b64_tr_b16 a[118:119], v237 offset:20992
    ds_read_b64_tr_b16 a[120:121], v238 offset:20480
    ds_read_b64_tr_b16 a[122:123], v238 offset:20992
    ds_read_b64_tr_b16 a[124:125], v239 offset:20480
    ds_read_b64_tr_b16 a[126:127], v239 offset:20992
    s_waitcnt vmcnt(14)
    s_waitcnt vmcnt(10)
    s_waitcnt vmcnt(6)
    s_waitcnt vmcnt(0)
    s_waitcnt lgkmcnt(0)
    s_barrier
    s_add_u32 m0, s5, 147456
    s_nop 0
    buffer_load_dwordx4 v8, s[28:31], s56 offen offset:0 lds
    buffer_load_dwordx4 v9, s[28:31], s56 offen offset:1024 lds
    buffer_load_dwordx4 v10, s[28:31], s56 offen offset:2048 lds
    buffer_load_dwordx4 v11, s[28:31], s56 offen offset:3072 lds
    s_add_u32 s56, s56, 524288
    s_cmp_ge_u32 s56, s58
    s_cselect_b32 s56, s57, s56
    s_add_u32 m0, s5, 49152
    s_nop 0
    buffer_load_dwordx4 v8, s[28:31], s56 offen offset:0 lds
    buffer_load_dwordx4 v9, s[28:31], s56 offen offset:1024 lds
    buffer_load_dwordx4 v10, s[28:31], s56 offen offset:2048 lds
    buffer_load_dwordx4 v11, s[28:31], s56 offen offset:3072 lds
    s_add_u32 s56, s56, 524288
    s_cmp_ge_u32 s56, s58
    s_cselect_b32 s56, s57, s56
    ds_read_b64_tr_b16 a[128:129], v232 offset:0
    ds_read_b64_tr_b16 a[130:131], v232 offset:512
    ds_read_b64_tr_b16 a[132:133], v233 offset:0
    ds_read_b64_tr_b16 a[134:135], v233 offset:512
    ds_read_b64_tr_b16 a[136:137], v234 offset:0
    ds_read_b64_tr_b16 a[138:139], v234 offset:512
    ds_read_b64_tr_b16 a[140:141], v235 offset:0
    ds_read_b64_tr_b16 a[142:143], v235 offset:512
    ds_read_b64_tr_b16 a[144:145], v232 offset:4096
    ds_read_b64_tr_b16 a[146:147], v232 offset:4608
    ds_read_b64_tr_b16 a[148:149], v233 offset:4096
    ds_read_b64_tr_b16 a[150:151], v233 offset:4608
    ds_read_b64_tr_b16 a[152:153], v234 offset:4096
    ds_read_b64_tr_b16 a[154:155], v234 offset:4608
    ds_read_b64_tr_b16 a[156:157], v235 offset:4096
    ds_read_b64_tr_b16 a[158:159], v235 offset:4608
    ds_read_b64_tr_b16 a[160:161], v232 offset:16384
    ds_read_b64_tr_b16 a[162:163], v232 offset:16896
    ds_read_b64_tr_b16 a[164:165], v233 offset:16384
    ds_read_b64_tr_b16 a[166:167], v233 offset:16896
    ds_read_b64_tr_b16 a[168:169], v234 offset:16384
    ds_read_b64_tr_b16 a[170:171], v234 offset:16896
    ds_read_b64_tr_b16 a[172:173], v235 offset:16384
    ds_read_b64_tr_b16 a[174:175], v235 offset:16896
    ds_read_b64_tr_b16 a[176:177], v232 offset:20480
    ds_read_b64_tr_b16 a[178:179], v232 offset:20992
    ds_read_b64_tr_b16 a[180:181], v233 offset:20480
    ds_read_b64_tr_b16 a[182:183], v233 offset:20992
    ds_read_b64_tr_b16 a[184:185], v234 offset:20480
    ds_read_b64_tr_b16 a[186:187], v234 offset:20992
    ds_read_b64_tr_b16 a[188:189], v235 offset:20480
    ds_read_b64_tr_b16 a[190:191], v235 offset:20992
    ds_read_b64_tr_b16 a[192:193], v232 offset:32768
    ds_read_b64_tr_b16 a[194:195], v232 offset:33280
    ds_read_b64_tr_b16 a[196:197], v233 offset:32768
    ds_read_b64_tr_b16 a[198:199], v233 offset:33280
    ds_read_b64_tr_b16 a[200:201], v234 offset:32768
    ds_read_b64_tr_b16 a[202:203], v234 offset:33280
    ds_read_b64_tr_b16 a[204:205], v235 offset:32768
    ds_read_b64_tr_b16 a[206:207], v235 offset:33280
    ds_read_b64_tr_b16 a[208:209], v232 offset:36864
    ds_read_b64_tr_b16 a[210:211], v232 offset:37376
    ds_read_b64_tr_b16 a[212:213], v233 offset:36864
    ds_read_b64_tr_b16 a[214:215], v233 offset:37376
    ds_read_b64_tr_b16 a[216:217], v234 offset:36864
    ds_read_b64_tr_b16 a[218:219], v234 offset:37376
    ds_read_b64_tr_b16 a[220:221], v235 offset:36864
    ds_read_b64_tr_b16 a[222:223], v235 offset:37376
    ds_read_b64_tr_b16 a[224:225], v240 offset:0
    ds_read_b64_tr_b16 a[226:227], v240 offset:512
    ds_read_b64_tr_b16 a[228:229], v241 offset:0
    ds_read_b64_tr_b16 a[230:231], v241 offset:512
    ds_read_b64_tr_b16 a[232:233], v242 offset:0
    ds_read_b64_tr_b16 a[234:235], v242 offset:512
    ds_read_b64_tr_b16 a[236:237], v243 offset:0
    ds_read_b64_tr_b16 a[238:239], v243 offset:512
    ds_read_b64_tr_b16 a[240:241], v240 offset:4096
    ds_read_b64_tr_b16 a[242:243], v240 offset:4608
    ds_read_b64_tr_b16 a[244:245], v241 offset:4096
    ds_read_b64_tr_b16 a[246:247], v241 offset:4608
    ds_read_b64_tr_b16 a[248:249], v242 offset:4096
    ds_read_b64_tr_b16 a[250:251], v242 offset:4608
    ds_read_b64_tr_b16 a[252:253], v243 offset:4096
    ds_read_b64_tr_b16 a[254:255], v243 offset:4608
    buffer_load_dwordx4 v[104:107], v16, s[36:39], s80 offen sc1
    buffer_load_dwordx4 v[108:111], v17, s[36:39], s80 offen sc1
    buffer_load_dwordx4 v[112:115], v18, s[36:39], s80 offen sc1
    buffer_load_dwordx4 v[116:119], v19, s[36:39], s80 offen sc1
    buffer_load_dwordx4 v[120:123], v16, s[36:39], s81 offen sc1
    buffer_load_dwordx4 v[124:127], v17, s[36:39], s81 offen sc1
    buffer_load_dwordx4 v[128:131], v18, s[36:39], s81 offen sc1
    buffer_load_dwordx4 v[132:135], v19, s[36:39], s81 offen sc1
    buffer_load_dwordx4 v[136:139], v16, s[36:39], s82 offen sc1
    buffer_load_dwordx4 v[140:143], v17, s[36:39], s82 offen sc1
    buffer_load_dwordx4 v[144:147], v18, s[36:39], s82 offen sc1
    buffer_load_dwordx4 v[148:151], v19, s[36:39], s82 offen sc1
    buffer_load_dwordx4 v[152:155], v16, s[36:39], s83 offen sc1
    buffer_load_dwordx4 v[156:159], v17, s[36:39], s83 offen sc1
    buffer_load_dwordx4 v[160:163], v18, s[36:39], s83 offen sc1
    buffer_load_dwordx4 v[164:167], v19, s[36:39], s83 offen sc1
    s_mov_b32 s75, 20000
    s_waitcnt vmcnt(12)
    v_max3_u32 v30, v104, v105, v106
    v_max3_u32 v31, v107, v108, v109
    v_max3_u32 v30, v30, v110, v111
    v_max3_u32 v31, v31, v112, v113
    v_max3_u32 v30, v30, v114, v115
    v_max3_u32 v31, v31, v116, v117
    v_max3_u32 v30, v30, v118, v119
    v_max_u32 v30, v30, v31
    v_cmp_eq_u32 vcc, -1, v30
    s_waitcnt lgkmcnt(0)
    s_cbranch_vccnz L_uretry0
L_uok0:
    v_mfma_f32_16x16x32_bf16 v[32:35], v[104:107], a[0:3], v[32:35]
    buffer_load_dwordx4 v[168:171], v16, s[36:39], s84 offen sc1
    v_mfma_f32_16x16x32_bf16 v[48:51], v[108:111], a[0:3], v[48:51]
    v_mfma_f32_16x16x32_bf16 v[36:39], v[104:107], a[4:7], v[36:39]
    v_mfma_f32_16x16x32_bf16 v[52:55], v[108:111], a[4:7], v[52:55]
    v_mfma_f32_16x16x32_bf16 v[40:43], v[104:107], a[8:11], v[40:43]
    buffer_load_dwordx4 v[172:175], v17, s[36:39], s84 offen sc1
    v_mfma_f32_16x16x32_bf16 v[56:59], v[108:111], a[8:11], v[56:59]
    v_mfma_f32_16x16x32_bf16 v[44:47], v[104:107], a[12:15], v[44:47]
    v_mfma_f32_16x16x32_bf16 v[60:63], v[108:111], a[12:15], v[60:63]
    v_mfma_f32_16x16x32_bf16 v[32:35], v[112:115], a[16:19], v[32:35]
    buffer_load_dwordx4 v[176:179], v18, s[36:39], s84 offen sc1
    v_mfma_f32_16x16x32_bf16 v[48:51], v[116:119], a[16:19], v[48:51]
    s_waitcnt vmcnt(11)
    v_max3_u32 v30, v120, v121, v122
    v_max3_u32 v31, v123, v124, v125
    v_mfma_f32_16x16x32_bf16 v[36:39], v[112:115], a[20:23], v[36:39]
    v_max3_u32 v30, v30, v126, v127
    v_max3_u32 v31, v31, v128, v129
    v_mfma_f32_16x16x32_bf16 v[52:55], v[116:119], a[20:23], v[52:55]
    v_max3_u32 v30, v30, v130, v131
    v_max3_u32 v31, v31, v132, v133
    v_mfma_f32_16x16x32_bf16 v[40:43], v[112:115], a[24:27], v[40:43]
    buffer_load_dwordx4 v[180:183], v19, s[36:39], s84 offen sc1
    v_max3_u32 v30, v30, v134, v135
    v_max_u32 v30, v30, v31
    v_mfma_f32_16x16x32_bf16 v[56:59], v[116:119], a[24:27], v[56:59]
    v_cmp_eq_u32 vcc, -1, v30
    v_mfma_f32_16x16x32_bf16 v[44:47], v[112:115], a[28:31], v[44:47]
    v_mfma_f32_16x16x32_bf16 v[60:63], v[116:119], a[28:31], v[60:63]
    s_add_u32 m0, s5, 65536
    s_nop 0
    buffer_load_dwordx4 v8, s[28:31], s56 offen offset:0 lds
    buffer_load_dwordx4 v9, s[28:31], s56 offen offset:1024 lds
    buffer_load_dwordx4 v10, s[28:31], s56 offen offset:2048 lds
    buffer_load_dwordx4 v11, s[28:31], s56 offen offset:3072 lds
    s_add_u32 s56, s56, 524288
    s_cmp_ge_u32 s56, s58
    s_cselect_b32 s56, s57, s56
    s_cbranch_vccnz L_uretry1
L_uok1:
    v_mfma_f32_16x16x32_bf16 v[32:35], v[120:123], a[32:35], v[32:35]
    buffer_load_dwordx4 v[184:187], v16, s[36:39], s85 offen sc1
    v_mfma_f32_16x16x32_bf16 v[48:51], v[124:127], a[32:35], v[48:51]
    v_mfma_f32_16x16x32_bf16 v[36:39], v[120:123], a[36:39], v[36:39]
    v_mfma_f32_16x16x32_bf16 v[52:55], v[124:127], a[36:39], v[52:55]
    v_mfma_f32_16x16x32_bf16 v[40:43], v[120:123], a[40:43], v[40:43]
    buffer_load_dwordx4 v[188:191], v17, s[36:39], s85 offen sc1
    v_mfma_f32_16x16x32_bf16 v[56:59], v[124:127], a[40:43], v[56:59]
    v_mfma_f32_16x16x32_bf16 v[44:47], v[120:123], a[44:47], v[44:47]
    v_mfma_f32_16x16x32_bf16 v[60:63], v[124:127], a[44:47], v[60:63]
    v_mfma_f32_16x16x32_bf16 v[32:35], v[128:131], a[48:51], v[32:35]
    buffer_load_dwordx4 v[192:195], v18, s[36:39], s85 offen sc1
    v_mfma_f32_16x16x32_bf16 v[48:51], v[132:135], a[48:51], v[48:51]
    s_waitcnt vmcnt(15)
    v_max3_u32 v30, v136, v137, v138
    v_max3_u32 v31, v139, v140, v141
    v_mfma_f32_16x16x32_bf16 v[36:39], v[128:131], a[52:55], v[36:39]
    v_max3_u32 v30, v30, v142, v143
    v_max3_u32 v31, v31, v144, v145
    v_mfma_f32_16x16x32_bf16 v[52:55], v[132:135], a[52:55], v[52:55]
    v_max3_u32 v30, v30, v146, v147
    v_max3_u32 v31, v31, v148, v149
    v_mfma_f32_16x16x32_bf16 v[40:43], v[128:131], a[56:59], v[40:43]
    buffer_load_dwordx4 v[196:199], v19, s[36:39], s85 offen sc1
    v_max3_u32 v30, v30, v150, v151
    v_max_u32 v30, v30, v31
    v_mfma_f32_16x16x32_bf16 v[56:59], v[132:135], a[56:59], v[56:59]
    v_cmp_eq_u32 vcc, -1, v30
    v_mfma_f32_16x16x32_bf16 v[44:47], v[128:131], a[60:63], v[44:47]
    v_mfma_f32_16x16x32_bf16 v[60:63], v[132:135], a[60:63], v[60:63]
    s_cbranch_vccnz L_uretry2
L_uok2:
    v_mfma_f32_16x16x32_bf16 v[32:35], v[136:139], a[64:67], v[32:35]
    buffer_load_dwordx4 v[200:203], v16, s[36:39], s86 offen sc1
    v_mfma_f32_16x16x32_bf16 v[48:51], v[140:143], a[64:67], v[48:51]
    v_mfma_f32_16x16x32_bf16 v[36:39], v[136:139], a[68:71], v[36:39]
    v_mfma_f32_16x16x32_bf16 v[52:55], v[140:143], a[68:71], v[52:55]
    v_mfma_f32_16x16x32_bf16 v[40:43], v[136:139], a[72:75], v[40:43]
    buffer_load_dwordx4 v[204:207], v17, s[36:39], s86 offen sc1
    v_mfma_f32_16x16x32_bf16 v[56:59], v[140:143], a[72:75], v[56:59]
    v_mfma_f32_16x16x32_bf16 v[44:47], v[136:139], a[76:79], v[44:47]
    v_mfma_f32_16x16x32_bf16 v[60:63], v[140:143], a[76:79], v[60:63]
    v_mfma_f32_16x16x32_bf16 v[32:35], v[144:147], a[80:83], v[32:35]
    buffer_load_dwordx4 v[208:211], v18, s[36:39], s86 offen sc1
    v_mfma_f32_16x16x32_bf16 v[48:51], v[148:151], a[80:83], v[48:51]
    s_waitcnt vmcnt(15)
    v_max3_u32 v30, v152, v153, v154
    v_max3_u32 v31, v155, v156, v157
    v_mfma_f32_16x16x32_bf16 v[36:39], v[144:147], a[84:87], v[36:39]
    v_max3_u32 v30, v30, v158, v159
    v_max3_u32 v31, v31, v160, v161
    v_mfma_f32_16x16x32_bf16 v[52:55], v[148:151], a[84:87], v[52:55]
    v_max3_u32 v30, v30, v162, v163
    v_max3_u32 v31, v31, v164, v165
    v_mfma_f32_16x16x32_bf16 v[40:43], v[144:147], a[88:91], v[40:43]
    buffer_load_dwordx4 v[212:215], v19, s[36:39], s86 offen sc1
    v_max3_u32 v30, v30, v166, v167
    v_max_u32 v30, v30, v31
    v_mfma_f32_16x16x32_bf16 v[56:59], v[148:151], a[88:91], v[56:59]
    v_cmp_eq_u32 vcc, -1, v30
    v_mfma_f32_16x16x32_bf16 v[44:47], v[144:147], a[92:95], v[44:47]
    v_mfma_f32_16x16x32_bf16 v[60:63], v[148:151], a[92:95], v[60:63]
    s_cbranch_vccnz L_uretry3
L_uok3:
    v_mfma_f32_16x16x32_bf16 v[32:35], v[152:155], a[96:99], v[32:35]
    buffer_load_dwordx4 v[216:219], v16, s[36:39], s87 offen sc1
    v_mfma_f32_16x16x32_bf16 v[48:51], v[156:159], a[96:99], v[48:51]
    v_mfma_f32_16x16x32_bf16 v[36:39], v[152:155], a[100:103], v[36:39]
    v_mfma_f32_16x16x32_bf16 v[52:55], v[156:159], a[100:103], v[52:55]
    v_mfma_f32_16x16x32_bf16 v[40:43], v[152:155], a[104:107], v[40:43]
    buffer_load_dwordx4 v[220:223], v17, s[36:39], s87 offen sc1
    v_mfma_f32_16x16x32_bf16 v[56:59], v[156:159], a[104:107], v[56:59]
    v_mfma_f32_16x16x32_bf16 v[44:47], v[152:155], a[108:111], v[44:47]
    v_mfma_f32_16x16x32_bf16 v[60:63], v[156:159], a[108:111], v[60:63]
    v_mfma_f32_16x16x32_bf16 v[32:35], v[160:163], a[112:115], v[32:35]
    buffer_load_dwordx4 v[224:227], v18, s[36:39], s87 offen sc1
    v_mfma_f32_16x16x32_bf16 v[48:51], v[164:167], a[112:115], v[48:51]
    s_waitcnt vmcnt(15)
    v_max3_u32 v30, v168, v169, v170
    v_max3_u32 v31, v171, v172, v173
    v_mfma_f32_16x16x32_bf16 v[36:39], v[160:163], a[116:119], v[36:39]
    v_max3_u32 v30, v30, v174, v175
    v_max3_u32 v31, v31, v176, v177
    v_mfma_f32_16x16x32_bf16 v[52:55], v[164:167], a[116:119], v[52:55]
    v_max3_u32 v30, v30, v178, v179
    v_max3_u32 v31, v31, v180, v181
    v_mfma_f32_16x16x32_bf16 v[40:43], v[160:163], a[120:123], v[40:43]
    buffer_load_dwordx4 v[228:231], v19, s[36:39], s87 offen sc1
    v_max3_u32 v30, v30, v182, v183
    v_max_u32 v30, v30, v31
    v_mfma_f32_16x16x32_bf16 v[56:59], v[164:167], a[120:123], v[56:59]
    v_cmp_eq_u32 vcc, -1, v30
    v_mfma_f32_16x16x32_bf16 v[44:47], v[160:163], a[124:127], v[44:47]
    v_mfma_f32_16x16x32_bf16 v[60:63], v[164:167], a[124:127], v[60:63]
    s_cbranch_vccnz L_uretry4
L_uok4:
    v_mfma_f32_16x16x32_bf16 v[32:35], v[168:171], a[128:131], v[32:35]
    buffer_load_dwordx4 v[104:107], v16, s[36:39], s88 offen sc1
    v_mfma_f32_16x16x32_bf16 v[48:51], v[172:175], a[128:131], v[48:51]
    v_mfma_f32_16x16x32_bf16 v[36:39], v[168:171], a[132:135], v[36:39]
    v_mfma_f32_16x16x32_bf16 v[52:55], v[172:175], a[132:135], v[52:55]
    v_mfma_f32_16x16x32_bf16 v[40:43], v[168:171], a[136:139], v[40:43]
    buffer_load_dwordx4 v[108:111], v17, s[36:39], s88 offen sc1
    v_mfma_f32_16x16x32_bf16 v[56:59], v[172:175], a[136:139], v[56:59]
    v_mfma_f32_16x16x32_bf16 v[44:47], v[168:171], a[140:143], v[44:47]
    v_mfma_f32_16x16x32_bf16 v[60:63], v[172:175], a[140:143], v[60:63]
    v_mfma_f32_16x16x32_bf16 v[32:35], v[176:179], a[144:147], v[32:35]
    buffer_load_dwordx4 v[112:115], v18, s[36:39], s88 offen sc1
    v_mfma_f32_16x16x32_bf16 v[48:51], v[180:183], a[144:147], v[48:51]
    s_waitcnt vmcnt(11)
    v_max3_u32 v30, v184, v185, v186
    v_max3_u32 v31, v187, v188, v189
    v_mfma_f32_16x16x32_bf16 v[36:39], v[176:179], a[148:151], v[36:39]
    v_max3_u32 v30, v30, v190, v191
    v_max3_u32 v31, v31, v192, v193
    v_mfma_f32_16x16x32_bf16 v[52:55], v[180:183], a[148:151], v[52:55]
    v_max3_u32 v30, v30, v194, v195
    v_max3_u32 v31, v31, v196, v197
    v_mfma_f32_16x16x32_bf16 v[40:43], v[176:179], a[152:155], v[40:43]
    buffer_load_dwordx4 v[116:119], v19, s[36:39], s88 offen sc1
    v_max3_u32 v30, v30, v198, v199
    v_max_u32 v30, v30, v31
    v_mfma_f32_16x16x32_bf16 v[56:59], v[180:183], a[152:155], v[56:59]
    v_cmp_eq_u32 vcc, -1, v30
    v_mfma_f32_16x16x32_bf16 v[44:47], v[176:179], a[156:159], v[44:47]
    v_mfma_f32_16x16x32_bf16 v[60:63], v[180:183], a[156:159], v[60:63]
    s_cbranch_vccnz L_uretry5
L_uok5:
    v_mfma_f32_16x16x32_bf16 v[32:35], v[184:187], a[160:163], v[32:35]
    buffer_load_dwordx4 v[120:123], v16, s[36:39], s89 offen sc1
    v_mfma_f32_16x16x32_bf16 v[48:51], v[188:191], a[160:163], v[48:51]
    v_mfma_f32_16x16x32_bf16 v[36:39], v[184:187], a[164:167], v[36:39]
    v_mfma_f32_16x16x32_bf16 v[52:55], v[188:191], a[164:167], v[52:55]
    v_mfma_f32_16x16x32_bf16 v[40:43], v[184:187], a[168:171], v[40:43]
    buffer_load_dwordx4 v[124:127], v17, s[36:39], s89 offen sc1
    v_mfma_f32_16x16x32_bf16 v[56:59], v[188:191], a[168:171], v[56:59]
    v_mfma_f32_16x16x32_bf16 v[44:47], v[184:187], a[172:175], v[44:47]
    v_mfma_f32_16x16x32_bf16 v[60:63], v[188:191], a[172:175], v[60:63]
    v_mfma_f32_16x16x32_bf16 v[32:35], v[192:195], a[176:179], v[32:35]
    buffer_load_dwordx4 v[128:131], v18, s[36:39], s89 offen sc1
    v_mfma_f32_16x16x32_bf16 v[48:51], v[196:199], a[176:179], v[48:51]
    s_waitcnt vmcnt(11)
    v_max3_u32 v30, v200, v201, v202
    v_max3_u32 v31, v203, v204, v205
    v_mfma_f32_16x16x32_bf16 v[36:39], v[192:195], a[180:183], v[36:39]
    v_max3_u32 v30, v30, v206, v207
    v_max3_u32 v31, v31, v208, v209
    v_mfma_f32_16x16x32_bf16 v[52:55], v[196:199], a[180:183], v[52:55]
    v_max3_u32 v30, v30, v210, v211
    v_max3_u32 v31, v31, v212, v213
    v_mfma_f32_16x16x32_bf16 v[40:43], v[192:195], a[184:187], v[40:43]
    buffer_load_dwordx4 v[132:135], v19, s[36:39], s89 offen sc1
    v_max3_u32 v30, v30, v214, v215
    v_max_u32 v30, v30, v31
    v_mfma_f32_16x16x32_bf16 v[56:59], v[196:199], a[184:187], v[56:59]
    v_cmp_eq_u32 vcc, -1, v30
    v_mfma_f32_16x16x32_bf16 v[44:47], v[192:195], a[188:191], v[44:47]
    v_mfma_f32_16x16x32_bf16 v[60:63], v[196:199], a[188:191], v[60:63]
    s_waitcnt lgkmcnt(0)
    s_barrier
    s_cbranch_vccnz L_uretry6
L_uok6:
    v_mfma_f32_16x16x32_bf16 v[32:35], v[200:203], a[192:195], v[32:35]
    buffer_load_dwordx4 v[136:139], v16, s[36:39], s90 offen sc1
    v_mfma_f32_16x16x32_bf16 v[48:51], v[204:207], a[192:195], v[48:51]
    v_mfma_f32_16x16x32_bf16 v[36:39], v[200:203], a[196:199], v[36:39]
    v_mfma_f32_16x16x32_bf16 v[52:55], v[204:207], a[196:199], v[52:55]
    v_mfma_f32_16x16x32_bf16 v[40:43], v[200:203], a[200:203], v[40:43]
    buffer_load_dwordx4 v[140:143], v17, s[36:39], s90 offen sc1
    v_mfma_f32_16x16x32_bf16 v[56:59], v[204:207], a[200:203], v[56:59]
    v_mfma_f32_16x16x32_bf16 v[44:47], v[200:203], a[204:207], v[44:47]
    v_mfma_f32_16x16x32_bf16 v[60:63], v[204:207], a[204:207], v[60:63]
    v_mfma_f32_16x16x32_bf16 v[32:35], v[208:211], a[208:211], v[32:35]
    buffer_load_dwordx4 v[144:147], v18, s[36:39], s90 offen sc1
    v_mfma_f32_16x16x32_bf16 v[48:51], v[212:215], a[208:211], v[48:51]
    s_waitcnt vmcnt(11)
    v_max3_u32 v30, v216, v217, v218
    v_max3_u32 v31, v219, v220, v221
    v_mfma_f32_16x16x32_bf16 v[36:39], v[208:211], a[212:215], v[36:39]
    v_max3_u32 v30, v30, v222, v223
    v_max3_u32 v31, v31, v224, v225
    v_mfma_f32_16x16x32_bf16 v[52:55], v[212:215], a[212:215], v[52:55]
    v_max3_u32 v30, v30, v226, v227
    v_max3_u32 v31, v31, v228, v229
    v_mfma_f32_16x16x32_bf16 v[40:43], v[208:211], a[216:219], v[40:43]
    buffer_load_dwordx4 v[148:151], v19, s[36:39], s90 offen sc1
    v_max3_u32 v30, v30, v230, v231
    v_max_u32 v30, v30, v31
    v_mfma_f32_16x16x32_bf16 v[56:59], v[212:215], a[216:219], v[56:59]
    v_cmp_eq_u32 vcc, -1, v30
    v_mfma_f32_16x16x32_bf16 v[44:47], v[208:211], a[220:223], v[44:47]
    v_mfma_f32_16x16x32_bf16 v[60:63], v[212:215], a[220:223], v[60:63]
    s_cbranch_vccnz L_uretry7
L_uok7:
    v_mfma_f32_16x16x32_bf16 v[32:35], v[216:219], a[224:227], v[32:35]
    v_mfma_f32_16x16x32_bf16 v[48:51], v[220:223], a[224:227], v[48:51]
    v_mfma_f32_16x16x32_bf16 v[36:39], v[216:219], a[228:231], v[36:39]
    v_mfma_f32_16x16x32_bf16 v[52:55], v[220:223], a[228:231], v[52:55]
    v_mfma_f32_16x16x32_bf16 v[40:43], v[216:219], a[232:235], v[40:43]
    v_mfma_f32_16x16x32_bf16 v[56:59], v[220:223], a[232:235], v[56:59]
    v_mfma_f32_16x16x32_bf16 v[44:47], v[216:219], a[236:239], v[44:47]
    v_mfma_f32_16x16x32_bf16 v[60:63], v[220:223], a[236:239], v[60:63]
    ds_read_b64_tr_b16 v[80:81], v240 offset:16384
    ds_read_b64_tr_b16 v[82:83], v240 offset:16896
    v_mfma_f32_16x16x32_bf16 v[32:35], v[224:227], a[240:243], v[32:35]
    v_mfma_f32_16x16x32_bf16 v[48:51], v[228:231], a[240:243], v[48:51]
    s_waitcnt vmcnt(8)
    v_max3_u32 v30, v104, v105, v106
    v_max3_u32 v31, v107, v108, v109
    ds_read_b64_tr_b16 v[84:85], v241 offset:16384
    ds_read_b64_tr_b16 v[86:87], v241 offset:16896
    v_mfma_f32_16x16x32_bf16 v[36:39], v[224:227], a[244:247], v[36:39]
    v_max3_u32 v30, v30, v110, v111
    v_max3_u32 v31, v31, v112, v113
    v_mfma_f32_16x16x32_bf16 v[52:55], v[228:231], a[244:247], v[52:55]
    v_max3_u32 v30, v30, v114, v115
    v_max3_u32 v31, v31, v116, v117
    ds_read_b64_tr_b16 v[88:89], v242 offset:16384
    ds_read_b64_tr_b16 v[90:91], v242 offset:16896
    v_mfma_f32_16x16x32_bf16 v[40:43], v[224:227], a[248:251], v[40:43]
    v_max3_u32 v30, v30, v118, v119
    v_max_u32 v30, v30, v31
    v_mfma_f32_16x16x32_bf16 v[56:59], v[228:231], a[248:251], v[56:59]
    v_cmp_eq_u32 vcc, -1, v30
    ds_read_b64_tr_b16 v[92:93], v243 offset:16384
    ds_read_b64_tr_b16 v[94:95], v243 offset:16896
    v_mfma_f32_16x16x32_bf16 v[44:47], v[224:227], a[252:255], v[44:47]
    v_mfma_f32_16x16x32_bf16 v[60:63], v[228:231], a[252:255], v[60:63]
    s_cbranch_vccnz L_uretry8
L_uok8:
    ds_read_b64_tr_b16 v[96:97], v240 offset:20480
    ds_read_b64_tr_b16 v[98:99], v240 offset:20992
    s_waitcnt lgkmcnt(8)
    v_mfma_f32_16x16x32_bf16 v[32:35], v[104:107], v[80:83], v[32:35]
    v_mfma_f32_16x16x32_bf16 v[48:51], v[108:111], v[80:83], v[48:51]
    ds_read_b64_tr_b16 v[100:101], v241 offset:20480
    ds_read_b64_tr_b16 v[102:103], v241 offset:20992
    s_waitcnt lgkmcnt(8)
    v_mfma_f32_16x16x32_bf16 v[36:39], v[104:107], v[84:87], v[36:39]
    v_mfma_f32_16x16x32_bf16 v[52:55], v[108:111], v[84:87], v[52:55]
    ds_read_b64_tr_b16 v[80:81], v242 offset:20480
    ds_read_b64_tr_b16 v[82:83], v242 offset:20992
    s_waitcnt lgkmcnt(8)
    v_mfma_f32_16x16x32_bf16 v[40:43], v[104:107], v[88:91], v[40:43]
    v_mfma_f32_16x16x32_bf16 v[56:59], v[108:111], v[88:91], v[56:59]
    ds_read_b64_tr_b16 v[84:85], v243 offset:20480
    ds_read_b64_tr_b16 v[86:87], v243 offset:20992
    s_waitcnt lgkmcnt(8)
    v_mfma_f32_16x16x32_bf16 v[44:47], v[104:107], v[92:95], v[44:47]
    v_mfma_f32_16x16x32_bf16 v[60:63], v[108:111], v[92:95], v[60:63]
    ds_read_b64_tr_b16 v[88:89], v232 offset:49152
    ds_read_b64_tr_b16 v[90:91], v232 offset:49664
    s_waitcnt lgkmcnt(8)
    v_mfma_f32_16x16x32_bf16 v[32:35], v[112:115], v[96:99], v[32:35]
    v_mfma_f32_16x16x32_bf16 v[48:51], v[116:119], v[96:99], v[48:51]
    s_waitcnt vmcnt(4)
    v_max3_u32 v30, v120, v121, v122
    v_max3_u32 v31, v123, v124, v125
    ds_read_b64_tr_b16 v[92:93], v233 offset:49152
    ds_read_b64_tr_b16 v[94:95], v233 offset:49664
    s_waitcnt lgkmcnt(8)
    v_mfma_f32_16x16x32_bf16 v[36:39], v[112:115], v[100:103], v[36:39]
    v_max3_u32 v30, v30, v126, v127
    v_max3_u32 v31, v31, v128, v129
    v_mfma_f32_16x16x32_bf16 v[52:55], v[116:119], v[100:103], v[52:55]
    v_max3_u32 v30, v30, v130, v131
    v_max3_u32 v31, v31, v132, v133
    ds_read_b64_tr_b16 v[96:97], v234 offset:49152
    ds_read_b64_tr_b16 v[98:99], v234 offset:49664
    s_waitcnt lgkmcnt(8)
    v_mfma_f32_16x16x32_bf16 v[40:43], v[112:115], v[80:83], v[40:43]
    v_max3_u32 v30, v30, v134, v135
    v_max_u32 v30, v30, v31
    v_mfma_f32_16x16x32_bf16 v[56:59], v[116:119], v[80:83], v[56:59]
    v_cmp_eq_u32 vcc, -1, v30
    ds_read_b64_tr_b16 v[100:101], v235 offset:49152
    ds_read_b64_tr_b16 v[102:103], v235 offset:49664
    s_waitcnt lgkmcnt(8)
    v_mfma_f32_16x16x32_bf16 v[44:47], v[112:115], v[84:87], v[44:47]
    v_mfma_f32_16x16x32_bf16 v[60:63], v[116:119], v[84:87], v[60:63]
    s_cbranch_vccnz L_uretry9
L_uok9:
    ds_read_b64_tr_b16 v[80:81], v232 offset:53248
    ds_read_b64_tr_b16 v[82:83], v232 offset:53760
    s_waitcnt lgkmcnt(8)
    v_mfma_f32_16x16x32_bf16 v[32:35], v[120:123], v[88:91], v[32:35]
    v_mfma_f32_16x16x32_bf16 v[48:51], v[124:127], v[88:91], v[48:51]
    ds_read_b64_tr_b16 v[84:85], v233 offset:53248
    ds_read_b64_tr_b16 v[86:87], v233 offset:53760
    s_waitcnt lgkmcnt(8)
    v_mfma_f32_16x16x32_bf16 v[36:39], v[120:123], v[92:95], v[36:39]
    v_mfma_f32_16x16x32_bf16 v[52:55], v[124:127], v[92:95], v[52:55]
    ds_read_b64_tr_b16 v[88:89], v234 offset:53248
    ds_read_b64_tr_b16 v[90:91], v234 offset:53760
    s_waitcnt lgkmcnt(8)
    v_mfma_f32_16x16x32_bf16 v[40:43], v[120:123], v[96:99], v[40:43]
    v_mfma_f32_16x16x32_bf16 v[56:59], v[124:127], v[96:99], v[56:59]
    ds_read_b64_tr_b16 v[92:93], v235 offset:53248
    ds_read_b64_tr_b16 v[94:95], v235 offset:53760
    s_waitcnt lgkmcnt(8)
    v_mfma_f32_16x16x32_bf16 v[44:47], v[120:123], v[100:103], v[44:47]
    v_mfma_f32_16x16x32_bf16 v[60:63], v[124:127], v[100:103], v[60:63]
    ds_read_b64_tr_b16 v[96:97], v236 offset:0
    ds_read_b64_tr_b16 v[98:99], v236 offset:512
    s_waitcnt lgkmcnt(8)
    v_mfma_f32_16x16x32_bf16 v[32:35], v[128:131], v[80:83], v[32:35]
    v_mfma_f32_16x16x32_bf16 v[48:51], v[132:135], v[80:83], v[48:51]
    s_waitcnt vmcnt(0)
    v_max3_u32 v30, v136, v137, v138
    v_max3_u32 v31, v139, v140, v141
    ds_read_b64_tr_b16 v[100:101], v237 offset:0
    ds_read_b64_tr_b16 v[102:103], v237 offset:512
    s_waitcnt lgkmcnt(8)
    v_mfma_f32_16x16x32_bf16 v[36:39], v[128:131], v[84:87], v[36:39]
    v_max3_u32 v30, v30, v142, v143
    v_max3_u32 v31, v31, v144, v145
    v_mfma_f32_16x16x32_bf16 v[52:55], v[132:135], v[84:87], v[52:55]
    v_max3_u32 v30, v30, v146, v147
    v_max3_u32 v31, v31, v148, v149
    ds_read_b64_tr_b16 v[80:81], v238 offset:0
    ds_read_b64_tr_b16 v[82:83], v238 offset:512
    s_waitcnt lgkmcnt(8)
    v_mfma_f32_16x16x32_bf16 v[40:43], v[128:131], v[88:91], v[40:43]
    v_max3_u32 v30, v30, v150, v151
    v_max_u32 v30, v30, v31
    v_mfma_f32_16x16x32_bf16 v[56:59], v[132:135], v[88:91], v[56:59]
    v_cmp_eq_u32 vcc, -1, v30
    ds_read_b64_tr_b16 v[84:85], v239 offset:0
    ds_read_b64_tr_b16 v[86:87], v239 offset:512
    s_waitcnt lgkmcnt(8)
    v_mfma_f32_16x16x32_bf16 v[44:47], v[128:131], v[92:95], v[44:47]
    v_mfma_f32_16x16x32_bf16 v[60:63], v[132:135], v[92:95], v[60:63]
    s_cbranch_vccnz L_uretry10
L_uok10:
    ds_read_b64_tr_b16 v[88:89], v236 offset:4096
    ds_read_b64_tr_b16 v[90:91], v236 offset:4608
    s_waitcnt lgkmcnt(8)
    v_mfma_f32_16x16x32_bf16 v[32:35], v[136:139], v[96:99], v[32:35]
    v_mfma_f32_16x16x32_bf16 v[48:51], v[140:143], v[96:99], v[48:51]
    ds_read_b64_tr_b16 v[92:93], v237 offset:4096
    ds_read_b64_tr_b16 v[94:95], v237 offset:4608
    s_waitcnt lgkmcnt(8)
    v_mfma_f32_16x16x32_bf16 v[36:39], v[136:139], v[100:103], v[36:39]
    v_mfma_f32_16x16x32_bf16 v[52:55], v[140:143], v[100:103], v[52:55]
    ds_read_b64_tr_b16 v[96:97], v238 offset:4096
    ds_read_b64_tr_b16 v[98:99], v238 offset:4608
    s_waitcnt lgkmcnt(8)
    v_mfma_f32_16x16x32_bf16 v[40:43], v[136:139], v[80:83], v[40:43]
    v_and_b32 v8, 1, v3
    v_lshrrev_b32 v9, 1, v3
    v_and_b32 v10, 15, v1
    v_lshlrev_b32 v30, 10, v10
    v_lshl_add_u32 v30, v8, 14, v30
    v_lshl_add_u32 v30, v9, 4, v30
    s_lshl_b32 s65, s63, 16
    s_lshl_b32 s3, s91, 5
    s_add_u32 s65, s65, s3
    s_lshl_b32 s3, s64, 7
    s_add_u32 s65, s65, s3
    s_add_u32 s66, s65, 32768
    v_mfma_f32_16x16x32_bf16 v[56:59], v[140:143], v[80:83], v[56:59]
    ds_read_b64_tr_b16 v[100:101], v239 offset:4096
    ds_read_b64_tr_b16 v[102:103], v239 offset:4608
    s_waitcnt lgkmcnt(8)
    v_mfma_f32_16x16x32_bf16 v[44:47], v[136:139], v[84:87], v[44:47]
    v_mfma_f32_16x16x32_bf16 v[60:63], v[140:143], v[84:87], v[60:63]
    s_waitcnt lgkmcnt(6)
    v_mfma_f32_16x16x32_bf16 v[48:51], v[148:151], v[88:91], v[48:51]
    s_waitcnt lgkmcnt(4)
    v_mfma_f32_16x16x32_bf16 v[52:55], v[148:151], v[92:95], v[52:55]
    s_waitcnt lgkmcnt(2)
    v_mfma_f32_16x16x32_bf16 v[56:59], v[148:151], v[96:99], v[56:59]
    s_waitcnt lgkmcnt(0)
    v_mfma_f32_16x16x32_bf16 v[60:63], v[148:151], v[100:103], v[60:63]
    v_mfma_f32_16x16x32_bf16 v[32:35], v[144:147], v[88:91], v[32:35]
    v_mfma_f32_16x16x32_bf16 v[36:39], v[144:147], v[92:95], v[36:39]
    v_mfma_f32_16x16x32_bf16 v[40:43], v[144:147], v[96:99], v[40:43]
    v_mfma_f32_16x16x32_bf16 v[44:47], v[144:147], v[100:103], v[44:47]
    s_nop 0
    ds_write_b128 v253, v[48:51] offset:0
    ds_write_b128 v253, v[52:55] offset:1024
    ds_write_b128 v253, v[56:59] offset:2048
    ds_write_b128 v253, v[60:63] offset:3072
    s_waitcnt lgkmcnt(0)
    s_barrier
    ds_read_b128 v[48:51], v254 offset:0
    ds_read_b128 v[52:55], v254 offset:1024
    ds_read_b128 v[56:59], v254 offset:2048
    ds_read_b128 v[60:63], v254 offset:3072
    s_waitcnt lgkmcnt(2)
    v_pk_add_f32 v[32:33], v[32:33], v[48:49]
    v_pk_add_f32 v[34:35], v[34:35], v[50:51]
    v_pk_add_f32 v[36:37], v[36:37], v[52:53]
    v_pk_add_f32 v[38:39], v[38:39], v[54:55]
    v_cvt_pk_bf16_f32 v64, v32, v33
    v_cvt_pk_bf16_f32 v65, v34, v35
    v_cvt_pk_bf16_f32 v66, v36, v37
    v_cvt_pk_bf16_f32 v67, v38, v39
    s_nop 1
    v_permlane16_swap_b32 v64, v66
    v_permlane16_swap_b32 v65, v67
    buffer_store_dwordx4 v[64:67], v30, s[40:43], s65 offen
    s_waitcnt lgkmcnt(0)
    v_pk_add_f32 v[40:41], v[40:41], v[56:57]
    v_pk_add_f32 v[42:43], v[42:43], v[58:59]
    v_pk_add_f32 v[44:45], v[44:45], v[60:61]
    v_pk_add_f32 v[46:47], v[46:47], v[62:63]
    v_cvt_pk_bf16_f32 v68, v40, v41
    v_cvt_pk_bf16_f32 v69, v42, v43
    v_cvt_pk_bf16_f32 v70, v44, v45
    v_cvt_pk_bf16_f32 v71, v46, v47
    s_nop 1
    v_permlane16_swap_b32 v68, v70
    v_permlane16_swap_b32 v69, v71
    buffer_store_dwordx4 v[68:71], v30, s[40:43], s66 offen
    s_or_b32 s3, s2, s60
    s_cmp_lg_u32 s3, 0
    s_cbranch_scc1 L_nobump
    s_mov_b32 s66, 4190208
    s_atomic_swap s97, s[18:19], s66
L_nobump:
L_end:
    s_endpgm
L_fretry0:
    s_mov_b32 s75, 20000
L_fr0:
    s_sleep 4
    buffer_load_dword v28, v29, s[44:47], s4 offen sc1
    s_waitcnt vmcnt(0)
    v_cmp_ne_u32 vcc, s97, v28
    s_cbranch_vccz L_fok0
    s_cmp_eq_u32 s75, 0
    s_cbranch_scc1 L_fok0
    s_sub_u32 s75, s75, 1
    s_branch L_fr0
L_fretry1:
    s_mov_b32 s75, 20000
L_fr1:
    s_sleep 4
    buffer_load_dword v28, v29, s[44:47], s4 offen sc1
    s_waitcnt vmcnt(0)
    v_cmp_ne_u32 vcc, s97, v28
    s_cbranch_vccz L_fok1
    s_cmp_eq_u32 s75, 0
    s_cbranch_scc1 L_fok1
    s_sub_u32 s75, s75, 1
    s_branch L_fr1
L_pxretry:
    s_cmp_eq_u32 s75, 0
    s_cbranch_scc1 L_pxok
    s_sub_u32 s75, s75, 1
    buffer_load_dwordx4 v[44:47], v7, s[8:11], s7 offen offset:0 sc1
    buffer_load_dwordx4 v[48:51], v7, s[8:11], s7 offen offset:1024 sc1
    buffer_load_dwordx4 v[52:55], v7, s[8:11], s7 offen offset:2048 sc1
    s_waitcnt vmcnt(0)
    s_branch L_pxchk
L_uretry0:
    s_cmp_eq_u32 s75, 0
    s_cbranch_scc1 L_uok0
    s_sub_u32 s75, s75, 1
    buffer_load_dwordx4 v[104:107], v16, s[36:39], s80 offen sc1
    buffer_load_dwordx4 v[108:111], v17, s[36:39], s80 offen sc1
    buffer_load_dwordx4 v[112:115], v18, s[36:39], s80 offen sc1
    buffer_load_dwordx4 v[116:119], v19, s[36:39], s80 offen sc1
    s_waitcnt vmcnt(0)
    v_max3_u32 v30, v104, v105, v106
    v_max3_u32 v31, v107, v108, v109
    v_max3_u32 v30, v30, v110, v111
    v_max3_u32 v31, v31, v112, v113
    v_max3_u32 v30, v30, v114, v115
    v_max3_u32 v31, v31, v116, v117
    v_max3_u32 v30, v30, v118, v119
    v_max_u32 v30, v30, v31
    v_cmp_eq_u32 vcc, -1, v30
    s_cbranch_vccnz L_uretry0
    s_branch L_uok0
L_uretry1:
    s_cmp_eq_u32 s75, 0
    s_cbranch_scc1 L_uok1
    s_sub_u32 s75, s75, 1
    buffer_load_dwordx4 v[120:123], v16, s[36:39], s81 offen sc1
    buffer_load_dwordx4 v[124:127], v17, s[36:39], s81 offen sc1
    buffer_load_dwordx4 v[128:131], v18, s[36:39], s81 offen sc1
    buffer_load_dwordx4 v[132:135], v19, s[36:39], s81 offen sc1
    s_waitcnt vmcnt(0)
    v_max3_u32 v30, v120, v121, v122
    v_max3_u32 v31, v123, v124, v125
    v_max3_u32 v30, v30, v126, v127
    v_max3_u32 v31, v31, v128, v129
    v_max3_u32 v30, v30, v130, v131
    v_max3_u32 v31, v31, v132, v133
    v_max3_u32 v30, v30, v134, v135
    v_max_u32 v30, v30, v31
    v_cmp_eq_u32 vcc, -1, v30
    s_cbranch_vccnz L_uretry1
    s_branch L_uok1
L_uretry2:
    s_cmp_eq_u32 s75, 0
    s_cbranch_scc1 L_uok2
    s_sub_u32 s75, s75, 1
    buffer_load_dwordx4 v[136:139], v16, s[36:39], s82 offen sc1
    buffer_load_dwordx4 v[140:143], v17, s[36:39], s82 offen sc1
    buffer_load_dwordx4 v[144:147], v18, s[36:39], s82 offen sc1
    buffer_load_dwordx4 v[148:151], v19, s[36:39], s82 offen sc1
    s_waitcnt vmcnt(0)
    v_max3_u32 v30, v136, v137, v138
    v_max3_u32 v31, v139, v140, v141
    v_max3_u32 v30, v30, v142, v143
    v_max3_u32 v31, v31, v144, v145
    v_max3_u32 v30, v30, v146, v147
    v_max3_u32 v31, v31, v148, v149
    v_max3_u32 v30, v30, v150, v151
    v_max_u32 v30, v30, v31
    v_cmp_eq_u32 vcc, -1, v30
    s_cbranch_vccnz L_uretry2
    s_branch L_uok2
L_uretry3:
    s_cmp_eq_u32 s75, 0
    s_cbranch_scc1 L_uok3
    s_sub_u32 s75, s75, 1
    buffer_load_dwordx4 v[152:155], v16, s[36:39], s83 offen sc1
    buffer_load_dwordx4 v[156:159], v17, s[36:39], s83 offen sc1
    buffer_load_dwordx4 v[160:163], v18, s[36:39], s83 offen sc1
    buffer_load_dwordx4 v[164:167], v19, s[36:39], s83 offen sc1
    s_waitcnt vmcnt(0)
    v_max3_u32 v30, v152, v153, v154
    v_max3_u32 v31, v155, v156, v157
    v_max3_u32 v30, v30, v158, v159
    v_max3_u32 v31, v31, v160, v161
    v_max3_u32 v30, v30, v162, v163
    v_max3_u32 v31, v31, v164, v165
    v_max3_u32 v30, v30, v166, v167
    v_max_u32 v30, v30, v31
    v_cmp_eq_u32 vcc, -1, v30
    s_cbranch_vccnz L_uretry3
    s_branch L_uok3
L_uretry4:
    s_cmp_eq_u32 s75, 0
    s_cbranch_scc1 L_uok4
    s_sub_u32 s75, s75, 1
    buffer_load_dwordx4 v[168:171], v16, s[36:39], s84 offen sc1
    buffer_load_dwordx4 v[172:175], v17, s[36:39], s84 offen sc1
    buffer_load_dwordx4 v[176:179], v18, s[36:39], s84 offen sc1
    buffer_load_dwordx4 v[180:183], v19, s[36:39], s84 offen sc1
    s_waitcnt vmcnt(0)
    v_max3_u32 v30, v168, v169, v170
    v_max3_u32 v31, v171, v172, v173
    v_max3_u32 v30, v30, v174, v175
    v_max3_u32 v31, v31, v176, v177
    v_max3_u32 v30, v30, v178, v179
    v_max3_u32 v31, v31, v180, v181
    v_max3_u32 v30, v30, v182, v183
    v_max_u32 v30, v30, v31
    v_cmp_eq_u32 vcc, -1, v30
    s_cbranch_vccnz L_uretry4
    s_branch L_uok4
L_uretry5:
    s_cmp_eq_u32 s75, 0
    s_cbranch_scc1 L_uok5
    s_sub_u32 s75, s75, 1
    buffer_load_dwordx4 v[184:187], v16, s[36:39], s85 offen sc1
    buffer_load_dwordx4 v[188:191], v17, s[36:39], s85 offen sc1
    buffer_load_dwordx4 v[192:195], v18, s[36:39], s85 offen sc1
    buffer_load_dwordx4 v[196:199], v19, s[36:39], s85 offen sc1
    s_waitcnt vmcnt(0)
    v_max3_u32 v30, v184, v185, v186
    v_max3_u32 v31, v187, v188, v189
    v_max3_u32 v30, v30, v190, v191
    v_max3_u32 v31, v31, v192, v193
    v_max3_u32 v30, v30, v194, v195
    v_max3_u32 v31, v31, v196, v197
    v_max3_u32 v30, v30, v198, v199
    v_max_u32 v30, v30, v31
    v_cmp_eq_u32 vcc, -1, v30
    s_cbranch_vccnz L_uretry5
    s_branch L_uok5
L_uretry6:
    s_cmp_eq_u32 s75, 0
    s_cbranch_scc1 L_uok6
    s_sub_u32 s75, s75, 1
    buffer_load_dwordx4 v[200:203], v16, s[36:39], s86 offen sc1
    buffer_load_dwordx4 v[204:207], v17, s[36:39], s86 offen sc1
    buffer_load_dwordx4 v[208:211], v18, s[36:39], s86 offen sc1
    buffer_load_dwordx4 v[212:215], v19, s[36:39], s86 offen sc1
    s_waitcnt vmcnt(0)
    v_max3_u32 v30, v200, v201, v202
    v_max3_u32 v31, v203, v204, v205
    v_max3_u32 v30, v30, v206, v207
    v_max3_u32 v31, v31, v208, v209
    v_max3_u32 v30, v30, v210, v211
    v_max3_u32 v31, v31, v212, v213
    v_max3_u32 v30, v30, v214, v215
    v_max_u32 v30, v30, v31
    v_cmp_eq_u32 vcc, -1, v30
    s_cbranch_vccnz L_uretry6
    s_branch L_uok6
L_uretry7:
    s_cmp_eq_u32 s75, 0
    s_cbranch_scc1 L_uok7
    s_sub_u32 s75, s75, 1
    buffer_load_dwordx4 v[216:219], v16, s[36:39], s87 offen sc1
    buffer_load_dwordx4 v[220:223], v17, s[36:39], s87 offen sc1
    buffer_load_dwordx4 v[224:227], v18, s[36:39], s87 offen sc1
    buffer_load_dwordx4 v[228:231], v19, s[36:39], s87 offen sc1
    s_waitcnt vmcnt(0)
    v_max3_u32 v30, v216, v217, v218
    v_max3_u32 v31, v219, v220, v221
    v_max3_u32 v30, v30, v222, v223
    v_max3_u32 v31, v31, v224, v225
    v_max3_u32 v30, v30, v226, v227
    v_max3_u32 v31, v31, v228, v229
    v_max3_u32 v30, v30, v230, v231
    v_max_u32 v30, v30, v31
    v_cmp_eq_u32 vcc, -1, v30
    s_cbranch_vccnz L_uretry7
    s_branch L_uok7
L_uretry8:
    s_cmp_eq_u32 s75, 0
    s_cbranch_scc1 L_uok8
    s_sub_u32 s75, s75, 1
    buffer_load_dwordx4 v[104:107], v16, s[36:39], s88 offen sc1
    buffer_load_dwordx4 v[108:111], v17, s[36:39], s88 offen sc1
    buffer_load_dwordx4 v[112:115], v18, s[36:39], s88 offen sc1
    buffer_load_dwordx4 v[116:119], v19, s[36:39], s88 offen sc1
    s_waitcnt vmcnt(0)
    v_max3_u32 v30, v104, v105, v106
    v_max3_u32 v31, v107, v108, v109
    v_max3_u32 v30, v30, v110, v111
    v_max3_u32 v31, v31, v112, v113
    v_max3_u32 v30, v30, v114, v115
    v_max3_u32 v31, v31, v116, v117
    v_max3_u32 v30, v30, v118, v119
    v_max_u32 v30, v30, v31
    v_cmp_eq_u32 vcc, -1, v30
    s_cbranch_vccnz L_uretry8
    s_branch L_uok8
L_uretry9:
    s_cmp_eq_u32 s75, 0
    s_cbranch_scc1 L_uok9
    s_sub_u32 s75, s75, 1
    buffer_load_dwordx4 v[120:123], v16, s[36:39], s89 offen sc1
    buffer_load_dwordx4 v[124:127], v17, s[36:39], s89 offen sc1
    buffer_load_dwordx4 v[128:131], v18, s[36:39], s89 offen sc1
    buffer_load_dwordx4 v[132:135], v19, s[36:39], s89 offen sc1
    s_waitcnt vmcnt(0)
    v_max3_u32 v30, v120, v121, v122
    v_max3_u32 v31, v123, v124, v125
    v_max3_u32 v30, v30, v126, v127
    v_max3_u32 v31, v31, v128, v129
    v_max3_u32 v30, v30, v130, v131
    v_max3_u32 v31, v31, v132, v133
    v_max3_u32 v30, v30, v134, v135
    v_max_u32 v30, v30, v31
    v_cmp_eq_u32 vcc, -1, v30
    s_cbranch_vccnz L_uretry9
    s_branch L_uok9
L_uretry10:
    s_cmp_eq_u32 s75, 0
    s_cbranch_scc1 L_uok10
    s_sub_u32 s75, s75, 1
    buffer_load_dwordx4 v[136:139], v16, s[36:39], s90 offen sc1
    buffer_load_dwordx4 v[140:143], v17, s[36:39], s90 offen sc1
    buffer_load_dwordx4 v[144:147], v18, s[36:39], s90 offen sc1
    buffer_load_dwordx4 v[148:151], v19, s[36:39], s90 offen sc1
    s_waitcnt vmcnt(0)
    v_max3_u32 v30, v136, v137, v138
    v_max3_u32 v31, v139, v140, v141
    v_max3_u32 v30, v30, v142, v143
    v_max3_u32 v31, v31, v144, v145
    v_max3_u32 v30, v30, v146, v147
    v_max3_u32 v31, v31, v148, v149
    v_max3_u32 v30, v30, v150, v151
    v_max_u32 v30, v30, v31
    v_cmp_eq_u32 vcc, -1, v30
    s_cbranch_vccnz L_uretry10
    s_branch L_uok10
L_code_end:
.section .rodata,"a"
.p2align 6
.amdhsa_kernel standalone__mixer_token_mlp__prompt_kernel
  .amdhsa_next_free_vgpr 512
  .amdhsa_next_free_sgpr 102
  .amdhsa_accum_offset 256
  .amdhsa_group_segment_fixed_size 0
  .amdhsa_kernarg_size 64
  .amdhsa_user_sgpr_count 2
  .amdhsa_user_sgpr_kernarg_segment_ptr 1
  .amdhsa_system_sgpr_workgroup_id_x 1
.end_amdhsa_kernel
```
